```python
import torch

def _softmax(x, axis=-1):
    return torch.softmax(x, dim=axis)
def _gelu(x):
    return torch.nn.functional.gelu(x, approximate="tanh")
def _silu(x):
    return torch.nn.functional.silu(x)
def _sigmoid(x):
    return torch.sigmoid(x)
def _layernorm(x, axis=-1, eps=1e-5):
    m = x.mean(dim=axis, keepdim=True)
    v = x.var(dim=axis, keepdim=True, unbiased=False)
    return (x - m) / torch.sqrt(v + eps)
def _scatter_add(tgt, idx, src, axis=0):
    return tgt.clone().index_add_(axis, idx, src)
def _segment_sum(src, seg, n):
    out = torch.zeros((n,) + src.shape[1:], dtype=src.dtype)
    return out.index_add_(0, seg, src)
def _pad(x, pw):
    flat = tuple(v for pair in reversed(pw) for v in pair)
    return torch.nn.functional.pad(x, flat)

kernel_name = 'gated_mix__compressed_kv_cla__gqa_block_cached__decode'

def setup_inputs():

    _w = (lambda a: (lambda t: t.to(torch.bfloat16) if t.is_floating_point() else t)(torch.as_tensor(a)))
    def _A_setup():
        B, H, Sq, Sk, D, M = 1, 32, 1, 16384, 128, 576
        Dc = 4 * D
        return {
            "x": _w((lambda *s: torch.randn(*s, dtype=torch.bfloat16) * 0.05)(B, Sq, M)),
            "c_kv": _w((lambda *s: torch.randn(*s, dtype=torch.bfloat16) * 0.2)(B, Sk, Dc)),
            "w_q": _w((lambda *s: torch.randn(*s, dtype=torch.bfloat16) * 3.2)(M, H, D) * (M ** -0.5)),
            "w_uk": _w((lambda *s: torch.randn(*s, dtype=torch.bfloat16) * 3.2)(Dc, H, D) * (Dc ** -0.5)),
            "w_uv": _w((lambda *s: torch.randn(*s, dtype=torch.bfloat16) * 0.2)(Dc, H, D) * (Dc ** -0.5)),
            "w_o": _w((lambda *s: torch.randn(*s, dtype=torch.bfloat16) * 0.2)(H, D, M) * ((H * D) ** -0.5)),
        }
    _A_in = _A_setup()

    def _B_setup():
        B, Sq, D = 1, 1, 576
        Hq, Hkv, Sk, Dh = 32, 16, 16384, 128
        assert Hq % Hkv == 0, (Hq, Hkv)
        return {
            "x": _w((lambda *s: torch.randn(*s, dtype=torch.bfloat16) * 0.05)(B, Sq, D)),
            "k_cache": _w((lambda *s: torch.randn(*s, dtype=torch.bfloat16) * 3.2)(B, Hkv, Sk, Dh)),
            "v_cache": _w((lambda *s: torch.randn(*s, dtype=torch.bfloat16) * 0.1)(B, Hkv, Sk, Dh)),
            "wq": _w((lambda *s: torch.randn(*s, dtype=torch.bfloat16) * 3.2)(D, Hq * Dh) * (D ** -0.5)),
            "wo": _w((lambda *s: torch.randn(*s, dtype=torch.bfloat16) * 0.1)(Hq * Dh, D) * ((Hq * Dh) ** -0.5)),
        }
    _B_in = _B_setup()

    return {
        "A_x": _A_in["x"],
        "A_c_kv": _A_in["c_kv"],
        "A_w_q": _A_in["w_q"],
        "A_w_uk": _A_in["w_uk"],
        "A_w_uv": _A_in["w_uv"],
        "A_w_o": _A_in["w_o"],
        "B_x": _B_in["x"],
        "B_k_cache": _B_in["k_cache"],
        "B_v_cache": _B_in["v_cache"],
        "B_wq": _B_in["wq"],
        "B_wo": _B_in["wo"],
        "gate_w": _w((lambda *s: torch.randn(*s, dtype=torch.bfloat16) * 0.05)(576) * 16.0),
    }

def reference(A_x, A_c_kv, A_w_q, A_w_uk, A_w_uv, A_w_o, B_x, B_k_cache, B_v_cache, B_wq, B_wo, gate_w):
    def _A_ref(x, c_kv, w_q, w_uk, w_uv, w_o):
        B, Sq, M = x.shape[0], x.shape[1], x.shape[2]
        Sk = c_kv.shape[1]
        H, D = w_q.shape[1], w_q.shape[2]
        q = torch.einsum("bqm,mhd->bhqd", x, w_q)
        k = torch.einsum("bkc,chd->bhkd", c_kv, w_uk)
        v = torch.einsum("bkc,chd->bhkd", c_kv, w_uv)
        scores = torch.einsum("bhqd,bhkd->bhqk", q, k) * (D ** -0.5)
        off = Sk - Sq
        qi = torch.arange(Sq)[:, None]
        kj = torch.arange(Sk)[None, :]
        cmask = kj <= (qi + off)
        scores = torch.where(cmask[None, None], scores, -1e9)
        p = _softmax(scores, axis=-1)
        ctx = torch.einsum("bhqk,bhkd->bhqd", p, v)
        return torch.einsum("bhqd,hdm->bqm", ctx, w_o)

    def _B_ref(x, k_cache, v_cache, wq, wo):
        B, Sq, D = x.shape
        Hq, Dh = 32, 128
        Hkv = k_cache.shape[1]
        rep = Hq // Hkv
        q = (lambda x, *d: x.permute(*d))((x @ wq).reshape(B, Sq, Hq, Dh), 0, 2, 1, 3)
        k = (lambda x, n, axis: torch.repeat_interleave(x, n, dim=axis))(k_cache, rep, axis=1)
        v = (lambda x, n, axis: torch.repeat_interleave(x, n, dim=axis))(v_cache, rep, axis=1)
        scores = torch.einsum("bhqd,bhkd->bhqk", q, k) * (Dh ** -0.5)
        p = _softmax(scores, axis=-1)
        o = torch.einsum("bhqk,bhkd->bhqd", p, v)
        return (lambda x, *d: x.permute(*d))(o, 0, 2, 1, 3).reshape(B, Sq, Hq * Dh) @ wo

    x = A_x
    g = _sigmoid((x * gate_w).sum(-1, keepdims=True))
    a = _A_ref(x, A_c_kv, A_w_q, A_w_uk, A_w_uv, A_w_o)
    b = _B_ref(x, B_k_cache, B_v_cache, B_wq, B_wo)
    return g * a + (1 - g) * b
```

```asm
; @launch grid=(256,1,1) block=(256,1,1) lds=163840
.amdgcn_target "amdgcn-amd-amdhsa--gfx950"
.text
.globl gated_mix__compressed_kv_cla__gqa_block_cached__decode_kernel
.p2align 8
.type gated_mix__compressed_kv_cla__gqa_block_cached__decode_kernel,@function
gated_mix__compressed_kv_cla__gqa_block_cached__decode_kernel:
    s_cmp_ge_u32 s2, 0x100
    s_cbranch_scc1 L_exit
    s_load_dwordx16 s[8:23], s[0:1], 0x0
    s_load_dwordx8 s[24:31], s[0:1], 0x40
    s_load_dwordx4 s[32:35], s[0:1], 0x60
    s_load_dwordx2 s[36:37], s[0:1], 0x70
    s_getpc_b64 s[40:41]
L_pc:
    s_mov_b32 s42, L_codeend-L_pc
    s_mov_b32 s43, 0x20000
    s_lshr_b32 s3, s2, 6
    s_lshl_b32 s3, s3, 14
    v_lshlrev_b32 v7, 6, v0
    v_add_u32 v7, s3, v7
    buffer_load_dword v255, v7, s[40:43], 0 offen
    v_and_b32 v1, 63, v0
    v_lshrrev_b32 v8, 6, v0
    v_lshlrev_b32 v6, 4, v1
    v_readfirstlane_b32 s4, v8
    s_mov_b32 s3, s2
    s_and_b32 s6, s3, 1
    s_mul_i32 s6, s6, 288
    s_mul_i32 s7, s4, 72
    s_add_u32 s6, s6, s7
    v_lshrrev_b32 v8, 3, v1
    v_add_u32 v7, s6, v8
    v_lshlrev_b32 v7, 1, v7
    v_and_b32 v9, 7, v1
    v_lshlrev_b32 v9, 4, v9
    v_lshlrev_b32 v8, 13, v8
    v_add_u32 v8, v8, v9
    s_lshl_b32 s87, s6, 13
    s_lshr_b32 s7, s3, 1
    s_and_b32 s7, s7, 63
    s_lshl_b32 s7, s7, 7
    s_add_u32 s87, s87, s7
    s_waitcnt lgkmcnt(0)
    s_load_dword s5, s[36:37], 0x0
    s_mov_b32 s44, s8
    s_mov_b32 s45, s9
    s_mov_b32 s46, 1152
    s_mov_b32 s47, 0x20000
    s_mov_b32 s52, s36
    s_mov_b32 s53, s37
    s_mov_b32 s54, 0x800000
    s_mov_b32 s55, 0x20000
    s_and_b32 s6, s3, 0x87
    s_lshl_b32 s7, s4, 8
    s_or_b32 s6, s6, s7
    s_cmp_lg_u32 s6, 0x80
    s_cbranch_scc1 L_cnt_1
    s_bfe_u32 s6, s3, 0x40003
    s_mul_i32 s6, s6, 256
    s_add_u32 s6, s6, 0x8000
    v_mov_b32 v9, 0
    s_mov_b64 exec, 1
    buffer_store_dword v9, v9, s[52:55], s6 offen sc0 sc1
    s_mov_b64 exec, -1
L_cnt_1:
    s_mov_b32 s21, s2
    s_cmp_ge_u32 s3, 0x80
    s_cselect_b32 s48, s26, s12
    s_cselect_b32 s49, s27, s13
    s_mov_b32 s50, 4718592
    s_mov_b32 s51, 0x20000
    buffer_load_ushort v204, v7, s[44:47], 0 offen offset:0
    buffer_load_ushort v205, v7, s[44:47], 0 offen offset:16
    buffer_load_ushort v206, v7, s[44:47], 0 offen offset:32
    buffer_load_ushort v207, v7, s[44:47], 0 offen offset:48
    buffer_load_ushort v208, v7, s[44:47], 0 offen offset:64
    buffer_load_ushort v209, v7, s[44:47], 0 offen offset:80
    buffer_load_ushort v210, v7, s[44:47], 0 offen offset:96
    buffer_load_ushort v211, v7, s[44:47], 0 offen offset:112
    buffer_load_ushort v212, v7, s[44:47], 0 offen offset:128
    buffer_load_dwordx4 v[168:171], v8, s[48:51], s87 offen nt
    s_add_u32 s87, s87, 0x10000
    buffer_load_dwordx4 v[172:175], v8, s[48:51], s87 offen nt
    s_add_u32 s87, s87, 0x10000
    buffer_load_dwordx4 v[176:179], v8, s[48:51], s87 offen nt
    s_add_u32 s87, s87, 0x10000
    buffer_load_dwordx4 v[180:183], v8, s[48:51], s87 offen nt
    s_add_u32 s87, s87, 0x10000
    buffer_load_dwordx4 v[184:187], v8, s[48:51], s87 offen nt
    s_add_u32 s87, s87, 0x10000
    buffer_load_dwordx4 v[188:191], v8, s[48:51], s87 offen nt
    s_add_u32 s87, s87, 0x10000
    buffer_load_dwordx4 v[192:195], v8, s[48:51], s87 offen nt
    s_add_u32 s87, s87, 0x10000
    buffer_load_dwordx4 v[196:199], v8, s[48:51], s87 offen nt
    s_add_u32 s87, s87, 0x10000
    buffer_load_dwordx4 v[200:203], v8, s[48:51], s87 offen nt
    s_mov_b32 s40, s14
    s_mov_b32 s41, s15
    s_mov_b32 s42, 4194304
    s_mov_b32 s43, 0x20000
    v_lshrrev_b32 v7, 4, v1
    v_lshlrev_b32 v7, 15, v7
    v_and_b32 v9, 15, v1
    v_lshlrev_b32 v9, 4, v9
    v_add_u32 v7, v7, v9
    s_and_b32 s6, s21, 7
    s_lshl_b32 s6, s6, 2
    s_add_u32 s6, s6, s4
    s_lshl_b32 s6, s6, 17
    s_lshr_b32 s7, s21, 3
    s_lshl_b32 s7, s7, 8
    s_add_u32 s6, s6, s7
    buffer_load_dwordx4 v[56:59], v7, s[40:43], s6 offen nt
    s_add_u32 s6, s6, 0x2000
    buffer_load_dwordx4 v[60:63], v7, s[40:43], s6 offen nt
    s_add_u32 s6, s6, 0x2000
    buffer_load_dwordx4 v[64:67], v7, s[40:43], s6 offen nt
    s_add_u32 s6, s6, 0x2000
    buffer_load_dwordx4 v[68:71], v7, s[40:43], s6 offen nt
    s_cmp_lt_u32 s2, 64
    s_cbranch_scc1 L_a_pre
    s_sub_u32 s86, s2, 64
    s_mul_i32 s84, s86, 5462
    s_lshr_b32 s84, s84, 16
    s_mul_i32 s6, s84, 12
    s_sub_u32 s85, s86, s6
    s_lshl_b32 s6, s85, 2
    s_add_u32 s6, s6, s4
    s_mul_i32 s87, s6, 69632
    s_lshl_b32 s7, s84, 22
    s_add_u32 s56, s22, s7
    s_addc_u32 s57, s23, 0
    s_mov_b32 s58, 0x400000
    s_mov_b32 s59, 0x20000
    s_add_u32 s60, s24, s7
    s_addc_u32 s61, s25, 0
    s_mov_b32 s62, 0x400000
    s_mov_b32 s63, 0x20000
    s_add_u32 s64, s22, s7
    s_addc_u32 s65, s23, 0
    s_mov_b32 s66, 0
    s_mov_b32 s67, 0x20000
    s_add_u32 s68, s24, s7
    s_addc_u32 s69, s25, 0
    s_mov_b32 s70, 0
    s_mov_b32 s71, 0x20000
    buffer_load_dwordx4 v[40:43], v6, s[56:59], s87 offen nt
    buffer_load_dwordx4 v[44:47], v6, s[56:59], s87 offen offset:1024 nt
    buffer_load_dwordx4 v[48:51], v6, s[56:59], s87 offen offset:2048 nt
    buffer_load_dwordx4 v[52:55], v6, s[56:59], s87 offen offset:3072 nt
    s_add_u32 s91, s84, 16
    s_mov_b32 s94, 0xff00ff00
    s_mov_b32 s95, 0xff00ff00
    s_waitcnt vmcnt(8)
    s_branch L_q
L_a_pre:
    s_mov_b32 s56, s24
    s_mov_b32 s57, s25
    s_mov_b32 s58, 0
    s_mov_b32 s59, 0x20000
    s_mov_b32 s64, s16
    s_mov_b32 s65, s17
    s_mov_b32 s66, 4194304
    s_mov_b32 s67, 0x20000
    s_mov_b32 s68, s24
    s_mov_b32 s69, s25
    s_mov_b32 s70, 0
    s_mov_b32 s71, 0x20000
    s_mul_i32 s7, s2, 262144
    s_add_u32 s60, s10, s7
    s_addc_u32 s61, s11, 0
    s_mov_b32 s62, 262144
    s_mov_b32 s63, 0x20000
    s_waitcnt vmcnt(4)
L_q:
    v_and_b32 v7, 1, v1
    v_lshlrev_b32 v7, 4, v7
    v_mov_b32 v8, 0xffff
    v_lshlrev_b32 v8, v7, v8
    s_mov_b32 s96, 0x3030303
    s_mov_b32 s97, 0x3030303
    v_cndmask_b32 v2, 0, v8, s[96:97]
    s_mov_b32 s96, 0xc0c0c0c
    s_mov_b32 s97, 0xc0c0c0c
    v_cndmask_b32 v3, 0, v8, s[96:97]
    s_mov_b32 s96, 0x30303030
    s_mov_b32 s97, 0x30303030
    v_cndmask_b32 v4, 0, v8, s[96:97]
    s_mov_b32 s96, 0xc0c0c0c0
    s_mov_b32 s97, 0xc0c0c0c0
    v_cndmask_b32 v5, 0, v8, s[96:97]
    v_lshl_or_b32 v204, v204, 16, v204
    v_lshl_or_b32 v205, v205, 16, v205
    v_lshl_or_b32 v206, v206, 16, v206
    v_lshl_or_b32 v207, v207, 16, v207
    v_lshl_or_b32 v208, v208, 16, v208
    v_lshl_or_b32 v209, v209, 16, v209
    v_lshl_or_b32 v210, v210, 16, v210
    v_lshl_or_b32 v211, v211, 16, v211
    v_lshl_or_b32 v212, v212, 16, v212
    v_and_b32 v214, v2, v204
    v_and_b32 v215, v3, v204
    v_and_b32 v216, v4, v204
    v_and_b32 v217, v5, v204
    s_nop 1
    v_mfma_f32_16x16x32_bf16 v[222:225], v[168:171], v[214:217], 0
    v_and_b32 v218, v2, v205
    v_and_b32 v219, v3, v205
    v_and_b32 v220, v4, v205
    v_and_b32 v221, v5, v205
    s_nop 1
    v_mfma_f32_16x16x32_bf16 v[222:225], v[172:175], v[218:221], v[222:225]
    v_and_b32 v214, v2, v206
    v_and_b32 v215, v3, v206
    v_and_b32 v216, v4, v206
    v_and_b32 v217, v5, v206
    s_nop 1
    v_mfma_f32_16x16x32_bf16 v[222:225], v[176:179], v[214:217], v[222:225]
    v_and_b32 v218, v2, v207
    v_and_b32 v219, v3, v207
    v_and_b32 v220, v4, v207
    v_and_b32 v221, v5, v207
    s_nop 1
    v_mfma_f32_16x16x32_bf16 v[222:225], v[180:183], v[218:221], v[222:225]
    v_and_b32 v214, v2, v208
    v_and_b32 v215, v3, v208
    v_and_b32 v216, v4, v208
    v_and_b32 v217, v5, v208
    s_nop 1
    v_mfma_f32_16x16x32_bf16 v[222:225], v[184:187], v[214:217], v[222:225]
    v_and_b32 v218, v2, v209
    v_and_b32 v219, v3, v209
    v_and_b32 v220, v4, v209
    v_and_b32 v221, v5, v209
    s_nop 1
    v_mfma_f32_16x16x32_bf16 v[222:225], v[188:191], v[218:221], v[222:225]
    v_and_b32 v214, v2, v210
    v_and_b32 v215, v3, v210
    v_and_b32 v216, v4, v210
    v_and_b32 v217, v5, v210
    s_nop 1
    v_mfma_f32_16x16x32_bf16 v[222:225], v[192:195], v[214:217], v[222:225]
    v_and_b32 v218, v2, v211
    v_and_b32 v219, v3, v211
    v_and_b32 v220, v4, v211
    v_and_b32 v221, v5, v211
    s_nop 1
    v_mfma_f32_16x16x32_bf16 v[222:225], v[196:199], v[218:221], v[222:225]
    v_and_b32 v214, v2, v212
    v_and_b32 v215, v3, v212
    v_and_b32 v216, v4, v212
    v_and_b32 v217, v5, v212
    s_nop 1
    v_mfma_f32_16x16x32_bf16 v[222:225], v[200:203], v[214:217], v[222:225]
    v_lshrrev_b32 v7, 4, v1
    v_and_b32 v8, 1, v7
    v_lshlrev_b32 v8, 10, v8
    v_lshrrev_b32 v7, 1, v7
    v_lshlrev_b32 v7, 2, v7
    v_add_u32 v7, v7, v8
    v_and_b32 v8, 7, v1
    v_lshlrev_b32 v8, 5, v8
    s_lshl_b32 s6, s4, 3
    s_add_u32 s6, s6, 131072
    v_add3_u32 v7, v7, v8, s6
    s_mov_b32 s96, 0xff00ff
    s_mov_b32 s97, 0xff00ff00
    s_mov_b64 exec, s[96:97]
    ds_write_b32 v7, v222 offset:0
    ds_write_b32 v7, v223 offset:256
    ds_write_b32 v7, v224 offset:512
    ds_write_b32 v7, v225 offset:768
    s_mov_b64 exec, -1
    s_waitcnt lgkmcnt(0)
    s_add_u32 s5, s5, 0x9e3779b1
    s_barrier
    s_cmp_lg_u32 s4, 0
    s_cbranch_scc1 L_qpub_2
    v_lshlrev_b32 v7, 5, v1
    v_add_u32 v7, 131072, v7
    ds_read_b128 v[226:229], v7
    ds_read_b128 v[230:233], v7 offset:16
    v_bfe_u32 v8, v1, 1, 2
    v_lshlrev_b32 v8, 10, v8
    v_lshrrev_b32 v9, 3, v1
    v_lshlrev_b32 v9, 4, v9
    v_add_u32 v8, v8, v9
    v_and_b32 v9, 1, v1
    v_lshlrev_b32 v9, 3, v9
    v_add_u32 v8, v8, v9
    s_lshr_b32 s6, s3, 3
    s_lshl_b32 s6, s6, 12
    s_bfe_u32 s7, s3, 0x10002
    s_lshl_b32 s7, s7, 9
    s_add_u32 s6, s6, s7
    s_and_b32 s7, s3, 1
    s_lshl_b32 s7, s7, 8
    s_add_u32 s6, s6, s7
    s_bfe_u32 s7, s3, 0x10001
    s_lshl_b32 s7, s7, 7
    s_add_u32 s6, s6, s7
    s_add_u32 s6, s6, 0x10000
    s_waitcnt lgkmcnt(0)
    v_add_f32 v226, v226, v227
    v_add_f32 v228, v228, v229
    v_add_f32 v230, v230, v231
    v_add_f32 v232, v232, v233
    v_add_f32 v226, v226, v228
    v_add_f32 v230, v230, v232
    v_add_f32 v226, v226, v230
    v_mul_f32 v226, 0x3e0293ee, v226
    v_mov_b32 v227, s5
    buffer_store_dwordx2 v[226:227], v8, s[52:55], s6 offen sc0 sc1
L_qpub_2:
    s_lshr_b32 s99, s21, 4
    s_lshl_b32 s99, s99, 12
    s_lshl_b32 s6, s4, 10
    s_add_u32 s6, s6, 0x10000
    s_add_u32 s99, s99, s6
    s_cmp_lt_u32 s2, 64
    s_cbranch_scc1 L_a_main
    s_lshl_b32 s91, s91, 12
    s_add_u32 s91, s91, s6
    s_and_b32 s6, s4, 1
    s_lshl_b32 s7, s84, 1
    s_add_u32 s6, s6, s7
    s_mul_i32 s6, s6, 147456
    s_lshl_b32 s7, s85, 7
    s_add_u32 s93, s6, s7
    s_cmp_ge_u32 s4, 2
    s_cselect_b32 s72, s18, s28
    s_cselect_b32 s73, s19, s29
    s_cmp_lt_u32 s85, 9
    s_cselect_b32 s74, 4718592, 0
    s_cselect_b32 s92, 1152, 0
    s_mov_b32 s75, 0x20000
    s_mov_b32 s76, s30
    s_mov_b32 s77, s31
    s_mov_b32 s78, s92
    s_mov_b32 s79, 0x20000
    s_mov_b32 s46, s92
    v_lshrrev_b32 v250, 3, v1
    v_mul_u32_u24 v250, 1152, v250
    v_and_b32 v8, 7, v1
    v_lshlrev_b32 v8, 4, v8
    v_add_u32 v250, v250, v8
    buffer_load_dwordx4 v[72:75], v6, s[60:63], s87 offen nt
    buffer_load_dwordx4 v[76:79], v6, s[60:63], s87 offen offset:1024 nt
    buffer_load_dwordx4 v[80:83], v6, s[60:63], s87 offen offset:2048 nt
    buffer_load_dwordx4 v[84:87], v6, s[60:63], s87 offen offset:3072 nt
    s_add_u32 s7, s87, 4096
    buffer_load_dwordx4 v[140:143], v6, s[56:59], s7 offen nt
    buffer_load_dwordx4 v[144:147], v6, s[56:59], s7 offen offset:1024 nt
    buffer_load_dwordx4 v[148:151], v6, s[56:59], s7 offen offset:2048 nt
    buffer_load_dwordx4 v[152:155], v6, s[56:59], s7 offen offset:3072 nt
    buffer_load_dwordx4 v[156:159], v6, s[60:63], s7 offen nt
    buffer_load_dwordx4 v[160:163], v6, s[60:63], s7 offen offset:1024 nt
    buffer_load_dwordx4 v[164:167], v6, s[60:63], s7 offen offset:2048 nt
    buffer_load_dwordx4 v[168:171], v6, s[60:63], s7 offen offset:3072 nt
    s_movk_i32 s88, 0x2000
L_x1_retry_3:
    buffer_load_dwordx4 v[88:91], v6, s[52:55], s99 offen sc1
    buffer_load_dwordx4 v[92:95], v6, s[52:55], s91 offen sc1
    s_waitcnt vmcnt(0)
    v_xor_b32 v242, s5, v89
    v_bitop3_b32 v242, v242, v91, s5 bitop3:0xf6
    v_bitop3_b32 v242, v242, v93, s5 bitop3:0xf6
    v_bitop3_b32 v242, v242, v95, s5 bitop3:0xf6
    v_cmp_ne_u32 vcc, 0, v242
    s_cbranch_vccz L_x1_ok_4
    s_sub_u32 s88, s88, 1
    s_cbranch_scc0 L_x1_retry_3
L_x1_ok_4:
    s_add_u32 s99, s87, 8192
    buffer_load_dwordx4 v[172:175], v6, s[56:59], s99 offen nt
    buffer_load_dwordx4 v[176:179], v6, s[56:59], s99 offen offset:1024 nt
    buffer_load_dwordx4 v[180:183], v6, s[56:59], s99 offen offset:2048 nt
    buffer_load_dwordx4 v[184:187], v6, s[56:59], s99 offen offset:3072 nt
    buffer_load_dwordx4 v[188:191], v6, s[60:63], s99 offen nt
    buffer_load_dwordx4 v[192:195], v6, s[60:63], s99 offen offset:1024 nt
    buffer_load_dwordx4 v[196:199], v6, s[60:63], s99 offen offset:2048 nt
    buffer_load_dwordx4 v[200:203], v6, s[60:63], s99 offen offset:3072 nt
    s_lshl_b32 s6, s4, 2
    s_add_u32 s6, s6, 135168
    v_add_u32 v7, s6, v6
    v_mov_b32 v89, v88
    v_mov_b32 v91, v90
    v_mov_b32 v93, v92
    v_mov_b32 v95, v94
    v_permlane16_swap_b32 v88, v89
    v_permlane16_swap_b32 v90, v91
    v_permlane16_swap_b32 v92, v93
    v_permlane16_swap_b32 v94, v95
    v_add_f32 v88, v88, v89
    v_add_f32 v90, v90, v91
    v_add_f32 v92, v92, v93
    v_add_f32 v94, v94, v95
    v_cvt_pk_bf16_f32 v88, v88, v90
    v_cvt_pk_bf16_f32 v92, v92, v94
    ds_write_b32 v7, v88 offset:0
    ds_write_b32 v7, v92 offset:1024
    v_add_u32 v7, 135168, v6
    s_waitcnt lgkmcnt(0)
    s_barrier
    s_bitcmp1_b32 s21, 3
    s_cselect_b64 s[96:97], -1, 0
    ds_read_b128 v[242:245], v7 offset:0
    s_waitcnt lgkmcnt(0)
    v_mov_b32 v246, v242
    v_mov_b32 v247, v243
    v_mov_b32 v248, v244
    v_mov_b32 v249, v245
    v_permlane32_swap_b32 v242, v246
    v_permlane32_swap_b32 v243, v247
    v_permlane32_swap_b32 v244, v248
    v_permlane32_swap_b32 v245, v249
    v_cndmask_b32 v16, v242, v246, s[96:97]
    v_cndmask_b32 v17, v243, v247, s[96:97]
    v_cndmask_b32 v18, v244, v248, s[96:97]
    v_cndmask_b32 v19, v245, v249, s[96:97]
    v_dot2_f32_bf16 v20, v56, v16, 0
    v_dot2_f32_bf16 v21, v60, v16, 0
    v_dot2_f32_bf16 v22, v64, v16, 0
    v_dot2_f32_bf16 v23, v68, v16, 0
    v_dot2_f32_bf16 v20, v57, v17, v20
    v_dot2_f32_bf16 v21, v61, v17, v21
    v_dot2_f32_bf16 v22, v65, v17, v22
    v_dot2_f32_bf16 v23, v69, v17, v23
    v_dot2_f32_bf16 v20, v58, v18, v20
    v_dot2_f32_bf16 v21, v62, v18, v21
    v_dot2_f32_bf16 v22, v66, v18, v22
    v_dot2_f32_bf16 v23, v70, v18, v23
    v_dot2_f32_bf16 v20, v59, v19, v20
    v_dot2_f32_bf16 v21, v63, v19, v21
    v_dot2_f32_bf16 v22, v67, v19, v22
    v_dot2_f32_bf16 v23, v71, v19, v23
    v_add_f32_dpp v20, v20, v20 row_ror:8 row_mask:0xf bank_mask:0xf
    v_add_f32_dpp v21, v21, v21 row_ror:8 row_mask:0xf bank_mask:0xf
    v_add_f32_dpp v22, v22, v22 row_ror:8 row_mask:0xf bank_mask:0xf
    v_add_f32_dpp v23, v23, v23 row_ror:8 row_mask:0xf bank_mask:0xf
    v_add_f32_dpp v20, v20, v20 quad_perm:[1,0,3,2] row_mask:0xf bank_mask:0xf
    v_add_f32_dpp v21, v21, v21 quad_perm:[1,0,3,2] row_mask:0xf bank_mask:0xf
    v_add_f32_dpp v22, v22, v22 quad_perm:[1,0,3,2] row_mask:0xf bank_mask:0xf
    v_add_f32_dpp v23, v23, v23 quad_perm:[1,0,3,2] row_mask:0xf bank_mask:0xf
    v_add_f32_dpp v20, v20, v20 quad_perm:[2,3,0,1] row_mask:0xf bank_mask:0xf
    v_add_f32_dpp v21, v21, v21 quad_perm:[2,3,0,1] row_mask:0xf bank_mask:0xf
    v_add_f32_dpp v22, v22, v22 quad_perm:[2,3,0,1] row_mask:0xf bank_mask:0xf
    v_add_f32_dpp v23, v23, v23 quad_perm:[2,3,0,1] row_mask:0xf bank_mask:0xf
    v_add_f32_dpp v20, v20, v20 row_half_mirror row_mask:0xf bank_mask:0xf
    v_add_f32_dpp v21, v21, v21 row_half_mirror row_mask:0xf bank_mask:0xf
    v_add_f32_dpp v22, v22, v22 row_half_mirror row_mask:0xf bank_mask:0xf
    v_add_f32_dpp v23, v23, v23 row_half_mirror row_mask:0xf bank_mask:0xf
    v_cvt_pk_bf16_f32 v24, v20, v21
    v_cvt_pk_bf16_f32 v26, v22, v23
    v_mov_b32 v25, s5
    v_mov_b32 v27, s5
    s_lshl_b32 s6, s21, 8
    s_lshl_b32 s7, s4, 6
    s_add_u32 s6, s6, s7
    s_add_u32 s6, s6, 0x30000
    s_mov_b32 s96, 0x10001
    s_mov_b32 s97, 0x10001
    s_mov_b64 exec, s[96:97]
    buffer_store_dwordx4 v[24:27], v1, s[52:55], s6 offen sc0 sc1
    s_mov_b64 exec, -1
    buffer_load_dwordx4 v[204:207], v6, s[44:47], 0 offen
    buffer_load_dwordx4 v[208:211], v6, s[44:47], 0 offen offset:1024
    buffer_load_dwordx4 v[212:215], v6, s[76:79], 0 offen
    buffer_load_dwordx4 v[216:219], v6, s[76:79], 0 offen offset:1024
    s_mul_i32 s20, s84, 256
    s_add_u32 s20, s20, 0x8000
    v_mov_b32 v134, 0
    s_lshl_b32 s6, s85, 2
    s_add_u32 s6, s6, s4
    s_sub_u32 s6, s6, 48
    v_mov_b32 v133, s6
    ds_read_b128 v[242:245], v7 offset:1024
    s_waitcnt lgkmcnt(0)
    v_mov_b32 v246, v242
    v_mov_b32 v247, v243
    v_mov_b32 v248, v244
    v_mov_b32 v249, v245
    v_permlane32_swap_b32 v242, v246
    v_permlane32_swap_b32 v243, v247
    v_permlane32_swap_b32 v244, v248
    v_permlane32_swap_b32 v245, v249
    v_cndmask_b32 v32, v242, v246, s[94:95]
    v_cndmask_b32 v36, v246, v242, s[94:95]
    v_cndmask_b32 v33, v243, v247, s[94:95]
    v_cndmask_b32 v37, v247, v243, s[94:95]
    v_cndmask_b32 v34, v244, v248, s[94:95]
    v_cndmask_b32 v38, v248, v244, s[94:95]
    v_cndmask_b32 v35, v245, v249, s[94:95]
    v_cndmask_b32 v39, v249, v245, s[94:95]
    v_mov_b32 v10, 0
    v_mov_b32 v11, 0
    v_mov_b32 v12, 0
    v_mov_b32 v13, 0
    v_mov_b32 v14, 0xff800000
    v_mov_b32 v15, 0
    s_add_u32 s99, s87, 12288
    s_waitcnt vmcnt(63)
    v_dot2_f32_bf16 v16, v40, v32, 0
    v_dot2_f32_bf16 v24, v40, v36, 0
    v_dot2_f32_bf16 v16, v41, v33, v16
    v_dot2_f32_bf16 v24, v41, v37, v24
    v_dot2_f32_bf16 v16, v42, v34, v16
    v_dot2_f32_bf16 v24, v42, v38, v24
    v_dot2_f32_bf16 v16, v43, v35, v16
    v_dot2_f32_bf16 v24, v43, v39, v24
    buffer_load_dwordx4 v[40:43], v6, s[56:59], s99 offen nt
    s_waitcnt vmcnt(63)
    v_dot2_f32_bf16 v17, v44, v32, 0
    v_dot2_f32_bf16 v25, v44, v36, 0
    v_dot2_f32_bf16 v17, v45, v33, v17
    v_dot2_f32_bf16 v25, v45, v37, v25
    v_dot2_f32_bf16 v17, v46, v34, v17
    v_dot2_f32_bf16 v25, v46, v38, v25
    v_dot2_f32_bf16 v17, v47, v35, v17
    v_dot2_f32_bf16 v25, v47, v39, v25
    buffer_load_dwordx4 v[44:47], v6, s[56:59], s99 offen offset:1024 nt
    s_waitcnt vmcnt(63)
    v_dot2_f32_bf16 v18, v48, v32, 0
    v_dot2_f32_bf16 v26, v48, v36, 0
    v_dot2_f32_bf16 v18, v49, v33, v18
    v_dot2_f32_bf16 v26, v49, v37, v26
    v_dot2_f32_bf16 v18, v50, v34, v18
    v_dot2_f32_bf16 v26, v50, v38, v26
    v_dot2_f32_bf16 v18, v51, v35, v18
    v_dot2_f32_bf16 v26, v51, v39, v26
    buffer_load_dwordx4 v[48:51], v6, s[56:59], s99 offen offset:2048 nt
    s_waitcnt vmcnt(63)
    v_dot2_f32_bf16 v19, v52, v32, 0
    v_dot2_f32_bf16 v27, v52, v36, 0
    v_dot2_f32_bf16 v19, v53, v33, v19
    v_dot2_f32_bf16 v27, v53, v37, v27
    v_dot2_f32_bf16 v19, v54, v34, v19
    v_dot2_f32_bf16 v27, v54, v38, v27
    v_dot2_f32_bf16 v19, v55, v35, v19
    v_dot2_f32_bf16 v27, v55, v39, v27
    buffer_load_dwordx4 v[52:55], v6, s[56:59], s99 offen offset:3072 nt
    v_add_f32_dpp v16, v24, v16 row_ror:8 row_mask:0xf bank_mask:0xf
    v_add_f32_dpp v17, v25, v17 row_ror:8 row_mask:0xf bank_mask:0xf
    v_add_f32_dpp v18, v26, v18 row_ror:8 row_mask:0xf bank_mask:0xf
    v_add_f32_dpp v19, v27, v19 row_ror:8 row_mask:0xf bank_mask:0xf
    v_add_f32_dpp v16, v16, v16 quad_perm:[1,0,3,2] row_mask:0xf bank_mask:0xf
    v_add_f32_dpp v17, v17, v17 quad_perm:[1,0,3,2] row_mask:0xf bank_mask:0xf
    v_add_f32_dpp v18, v18, v18 quad_perm:[1,0,3,2] row_mask:0xf bank_mask:0xf
    v_add_f32_dpp v19, v19, v19 quad_perm:[1,0,3,2] row_mask:0xf bank_mask:0xf
    v_add_f32_dpp v16, v16, v16 quad_perm:[2,3,0,1] row_mask:0xf bank_mask:0xf
    v_add_f32_dpp v17, v17, v17 quad_perm:[2,3,0,1] row_mask:0xf bank_mask:0xf
    v_add_f32_dpp v18, v18, v18 quad_perm:[2,3,0,1] row_mask:0xf bank_mask:0xf
    v_add_f32_dpp v19, v19, v19 quad_perm:[2,3,0,1] row_mask:0xf bank_mask:0xf
    v_add_f32_dpp v16, v16, v16 row_half_mirror row_mask:0xf bank_mask:0xf
    v_add_f32_dpp v17, v17, v17 row_half_mirror row_mask:0xf bank_mask:0xf
    v_add_f32_dpp v18, v18, v18 row_half_mirror row_mask:0xf bank_mask:0xf
    v_add_f32_dpp v19, v19, v19 row_half_mirror row_mask:0xf bank_mask:0xf
    v_max_f32 v130, v16, v17
    v_max3_f32 v130, v130, v18, v19
    v_mov_b32 v131, v130
    s_nop 1
    v_permlane16_swap_b32 v130, v131
    v_max_f32 v130, v130, v131
    v_mov_b32 v131, v130
    s_nop 1
    v_permlane32_swap_b32 v130, v131
    v_max_f32 v130, v130, v131
    v_max_f32 v130, v130, v14
    v_sub_f32 v132, v14, v130
    v_sub_f32 v16, v16, v130
    v_sub_f32 v17, v17, v130
    v_sub_f32 v18, v18, v130
    v_sub_f32 v19, v19, v130
    v_exp_f32 v132, v132
    v_exp_f32 v16, v16
    v_exp_f32 v17, v17
    v_exp_f32 v18, v18
    v_exp_f32 v19, v19
    v_mov_b32 v14, v130
    v_mul_f32 v15, v15, v132
    v_mul_f32 v10, v10, v132
    v_mul_f32 v11, v11, v132
    v_mul_f32 v12, v12, v132
    v_mul_f32 v13, v13, v132
    v_cvt_pk_bf16_f32 v24, v16, v16
    v_cvt_pk_bf16_f32 v25, v17, v17
    v_cvt_pk_bf16_f32 v26, v18, v18
    v_cvt_pk_bf16_f32 v27, v19, v19
    v_add_f32 v15, v15, v16
    v_add_f32 v15, v15, v17
    v_add_f32 v15, v15, v18
    v_add_f32 v15, v15, v19
    v_and_b32 v122, v2, v24
    v_and_b32 v123, v3, v24
    v_and_b32 v124, v4, v24
    v_and_b32 v125, v5, v24
    s_waitcnt vmcnt(63)
    s_nop 0
    v_mfma_f32_16x16x32_bf16 v[10:13], v[72:75], v[122:125], v[10:13]
    buffer_load_dwordx4 v[72:75], v6, s[60:63], s99 offen nt
    v_and_b32 v126, v2, v25
    v_and_b32 v127, v3, v25
    v_and_b32 v128, v4, v25
    v_and_b32 v129, v5, v25
    s_waitcnt vmcnt(63)
    s_nop 0
    v_mfma_f32_16x16x32_bf16 v[10:13], v[76:79], v[126:129], v[10:13]
    buffer_load_dwordx4 v[76:79], v6, s[60:63], s99 offen offset:1024 nt
    v_and_b32 v122, v2, v26
    v_and_b32 v123, v3, v26
    v_and_b32 v124, v4, v26
    v_and_b32 v125, v5, v26
    s_waitcnt vmcnt(63)
    s_nop 0
    v_mfma_f32_16x16x32_bf16 v[10:13], v[80:83], v[122:125], v[10:13]
    buffer_load_dwordx4 v[80:83], v6, s[60:63], s99 offen offset:2048 nt
    v_and_b32 v126, v2, v27
    v_and_b32 v127, v3, v27
    v_and_b32 v128, v4, v27
    v_and_b32 v129, v5, v27
    s_waitcnt vmcnt(63)
    s_nop 0
    v_mfma_f32_16x16x32_bf16 v[10:13], v[84:87], v[126:129], v[10:13]
    buffer_load_dwordx4 v[84:87], v6, s[60:63], s99 offen offset:3072 nt
    s_waitcnt vmcnt(63)
    v_dot2_f32_bf16 v16, v140, v32, 0
    v_dot2_f32_bf16 v24, v140, v36, 0
    v_dot2_f32_bf16 v16, v141, v33, v16
    v_dot2_f32_bf16 v24, v141, v37, v24
    v_dot2_f32_bf16 v16, v142, v34, v16
    v_dot2_f32_bf16 v24, v142, v38, v24
    v_dot2_f32_bf16 v16, v143, v35, v16
    v_dot2_f32_bf16 v24, v143, v39, v24
    s_waitcnt vmcnt(63)
    v_dot2_f32_bf16 v17, v144, v32, 0
    v_dot2_f32_bf16 v25, v144, v36, 0
    v_dot2_f32_bf16 v17, v145, v33, v17
    v_dot2_f32_bf16 v25, v145, v37, v25
    v_dot2_f32_bf16 v17, v146, v34, v17
    v_dot2_f32_bf16 v25, v146, v38, v25
    v_dot2_f32_bf16 v17, v147, v35, v17
    v_dot2_f32_bf16 v25, v147, v39, v25
    s_waitcnt vmcnt(63)
    v_dot2_f32_bf16 v18, v148, v32, 0
    v_dot2_f32_bf16 v26, v148, v36, 0
    v_dot2_f32_bf16 v18, v149, v33, v18
    v_dot2_f32_bf16 v26, v149, v37, v26
    v_dot2_f32_bf16 v18, v150, v34, v18
    v_dot2_f32_bf16 v26, v150, v38, v26
    v_dot2_f32_bf16 v18, v151, v35, v18
    v_dot2_f32_bf16 v26, v151, v39, v26
    s_waitcnt vmcnt(63)
    v_dot2_f32_bf16 v19, v152, v32, 0
    v_dot2_f32_bf16 v27, v152, v36, 0
    v_dot2_f32_bf16 v19, v153, v33, v19
    v_dot2_f32_bf16 v27, v153, v37, v27
    v_dot2_f32_bf16 v19, v154, v34, v19
    v_dot2_f32_bf16 v27, v154, v38, v27
    v_dot2_f32_bf16 v19, v155, v35, v19
    v_dot2_f32_bf16 v27, v155, v39, v27
    v_add_f32_dpp v16, v24, v16 row_ror:8 row_mask:0xf bank_mask:0xf
    v_add_f32_dpp v17, v25, v17 row_ror:8 row_mask:0xf bank_mask:0xf
    v_add_f32_dpp v18, v26, v18 row_ror:8 row_mask:0xf bank_mask:0xf
    v_add_f32_dpp v19, v27, v19 row_ror:8 row_mask:0xf bank_mask:0xf
    v_add_f32_dpp v16, v16, v16 quad_perm:[1,0,3,2] row_mask:0xf bank_mask:0xf
    v_add_f32_dpp v17, v17, v17 quad_perm:[1,0,3,2] row_mask:0xf bank_mask:0xf
    v_add_f32_dpp v18, v18, v18 quad_perm:[1,0,3,2] row_mask:0xf bank_mask:0xf
    v_add_f32_dpp v19, v19, v19 quad_perm:[1,0,3,2] row_mask:0xf bank_mask:0xf
    v_add_f32_dpp v16, v16, v16 quad_perm:[2,3,0,1] row_mask:0xf bank_mask:0xf
    v_add_f32_dpp v17, v17, v17 quad_perm:[2,3,0,1] row_mask:0xf bank_mask:0xf
    v_add_f32_dpp v18, v18, v18 quad_perm:[2,3,0,1] row_mask:0xf bank_mask:0xf
    v_add_f32_dpp v19, v19, v19 quad_perm:[2,3,0,1] row_mask:0xf bank_mask:0xf
    v_add_f32_dpp v16, v16, v16 row_half_mirror row_mask:0xf bank_mask:0xf
    v_add_f32_dpp v17, v17, v17 row_half_mirror row_mask:0xf bank_mask:0xf
    v_add_f32_dpp v18, v18, v18 row_half_mirror row_mask:0xf bank_mask:0xf
    v_add_f32_dpp v19, v19, v19 row_half_mirror row_mask:0xf bank_mask:0xf
    v_max_f32 v130, v16, v17
    v_max3_f32 v130, v130, v18, v19
    v_mov_b32 v131, v130
    s_nop 1
    v_permlane16_swap_b32 v130, v131
    v_max_f32 v130, v130, v131
    v_mov_b32 v131, v130
    s_nop 1
    v_permlane32_swap_b32 v130, v131
    v_max_f32 v130, v130, v131
    v_max_f32 v130, v130, v14
    v_sub_f32 v132, v14, v130
    v_sub_f32 v16, v16, v130
    v_sub_f32 v17, v17, v130
    v_sub_f32 v18, v18, v130
    v_sub_f32 v19, v19, v130
    v_exp_f32 v132, v132
    v_exp_f32 v16, v16
    v_exp_f32 v17, v17
    v_exp_f32 v18, v18
    v_exp_f32 v19, v19
    v_mov_b32 v14, v130
    v_mul_f32 v15, v15, v132
    v_mul_f32 v10, v10, v132
    v_mul_f32 v11, v11, v132
    v_mul_f32 v12, v12, v132
    v_mul_f32 v13, v13, v132
    v_cvt_pk_bf16_f32 v24, v16, v16
    v_cvt_pk_bf16_f32 v25, v17, v17
    v_cvt_pk_bf16_f32 v26, v18, v18
    v_cvt_pk_bf16_f32 v27, v19, v19
    v_add_f32 v15, v15, v16
    v_add_f32 v15, v15, v17
    v_add_f32 v15, v15, v18
    v_add_f32 v15, v15, v19
    v_and_b32 v122, v2, v24
    v_and_b32 v123, v3, v24
    v_and_b32 v124, v4, v24
    v_and_b32 v125, v5, v24
    s_waitcnt vmcnt(63)
    s_nop 0
    v_mfma_f32_16x16x32_bf16 v[10:13], v[156:159], v[122:125], v[10:13]
    v_and_b32 v126, v2, v25
    v_and_b32 v127, v3, v25
    v_and_b32 v128, v4, v25
    v_and_b32 v129, v5, v25
    s_waitcnt vmcnt(63)
    s_nop 0
    v_mfma_f32_16x16x32_bf16 v[10:13], v[160:163], v[126:129], v[10:13]
    v_and_b32 v122, v2, v26
    v_and_b32 v123, v3, v26
    v_and_b32 v124, v4, v26
    v_and_b32 v125, v5, v26
    s_waitcnt vmcnt(63)
    s_nop 0
    v_mfma_f32_16x16x32_bf16 v[10:13], v[164:167], v[122:125], v[10:13]
    v_and_b32 v126, v2, v27
    v_and_b32 v127, v3, v27
    v_and_b32 v128, v4, v27
    v_and_b32 v129, v5, v27
    s_waitcnt vmcnt(63)
    s_nop 0
    v_mfma_f32_16x16x32_bf16 v[10:13], v[168:171], v[126:129], v[10:13]
    s_waitcnt vmcnt(20)
    v_dot2_f32_bf16 v16, v172, v32, 0
    v_dot2_f32_bf16 v24, v172, v36, 0
    v_dot2_f32_bf16 v16, v173, v33, v16
    v_dot2_f32_bf16 v24, v173, v37, v24
    v_dot2_f32_bf16 v16, v174, v34, v16
    v_dot2_f32_bf16 v24, v174, v38, v24
    v_dot2_f32_bf16 v16, v175, v35, v16
    v_dot2_f32_bf16 v24, v175, v39, v24
    s_waitcnt vmcnt(19)
    v_dot2_f32_bf16 v17, v176, v32, 0
    v_dot2_f32_bf16 v25, v176, v36, 0
    v_dot2_f32_bf16 v17, v177, v33, v17
    v_dot2_f32_bf16 v25, v177, v37, v25
    v_dot2_f32_bf16 v17, v178, v34, v17
    v_dot2_f32_bf16 v25, v178, v38, v25
    v_dot2_f32_bf16 v17, v179, v35, v17
    v_dot2_f32_bf16 v25, v179, v39, v25
    s_waitcnt vmcnt(18)
    v_dot2_f32_bf16 v18, v180, v32, 0
    v_dot2_f32_bf16 v26, v180, v36, 0
    v_dot2_f32_bf16 v18, v181, v33, v18
    v_dot2_f32_bf16 v26, v181, v37, v26
    v_dot2_f32_bf16 v18, v182, v34, v18
    v_dot2_f32_bf16 v26, v182, v38, v26
    v_dot2_f32_bf16 v18, v183, v35, v18
    v_dot2_f32_bf16 v26, v183, v39, v26
    s_waitcnt vmcnt(17)
    v_dot2_f32_bf16 v19, v184, v32, 0
    v_dot2_f32_bf16 v27, v184, v36, 0
    v_dot2_f32_bf16 v19, v185, v33, v19
    v_dot2_f32_bf16 v27, v185, v37, v27
    v_dot2_f32_bf16 v19, v186, v34, v19
    v_dot2_f32_bf16 v27, v186, v38, v27
    v_dot2_f32_bf16 v19, v187, v35, v19
    v_dot2_f32_bf16 v27, v187, v39, v27
    v_add_f32_dpp v16, v24, v16 row_ror:8 row_mask:0xf bank_mask:0xf
    v_add_f32_dpp v17, v25, v17 row_ror:8 row_mask:0xf bank_mask:0xf
    v_add_f32_dpp v18, v26, v18 row_ror:8 row_mask:0xf bank_mask:0xf
    v_add_f32_dpp v19, v27, v19 row_ror:8 row_mask:0xf bank_mask:0xf
    v_add_f32_dpp v16, v16, v16 quad_perm:[1,0,3,2] row_mask:0xf bank_mask:0xf
    v_add_f32_dpp v17, v17, v17 quad_perm:[1,0,3,2] row_mask:0xf bank_mask:0xf
    v_add_f32_dpp v18, v18, v18 quad_perm:[1,0,3,2] row_mask:0xf bank_mask:0xf
    v_add_f32_dpp v19, v19, v19 quad_perm:[1,0,3,2] row_mask:0xf bank_mask:0xf
    v_add_f32_dpp v16, v16, v16 quad_perm:[2,3,0,1] row_mask:0xf bank_mask:0xf
    v_add_f32_dpp v17, v17, v17 quad_perm:[2,3,0,1] row_mask:0xf bank_mask:0xf
    v_add_f32_dpp v18, v18, v18 quad_perm:[2,3,0,1] row_mask:0xf bank_mask:0xf
    v_add_f32_dpp v19, v19, v19 quad_perm:[2,3,0,1] row_mask:0xf bank_mask:0xf
    v_add_f32_dpp v16, v16, v16 row_half_mirror row_mask:0xf bank_mask:0xf
    v_add_f32_dpp v17, v17, v17 row_half_mirror row_mask:0xf bank_mask:0xf
    v_add_f32_dpp v18, v18, v18 row_half_mirror row_mask:0xf bank_mask:0xf
    v_add_f32_dpp v19, v19, v19 row_half_mirror row_mask:0xf bank_mask:0xf
    v_max_f32 v130, v16, v17
    v_max3_f32 v130, v130, v18, v19
    v_mov_b32 v131, v130
    s_nop 1
    v_permlane16_swap_b32 v130, v131
    v_max_f32 v130, v130, v131
    v_mov_b32 v131, v130
    s_nop 1
    v_permlane32_swap_b32 v130, v131
    v_max_f32 v130, v130, v131
    v_max_f32 v130, v130, v14
    v_sub_f32 v132, v14, v130
    v_sub_f32 v16, v16, v130
    v_sub_f32 v17, v17, v130
    v_sub_f32 v18, v18, v130
    v_sub_f32 v19, v19, v130
    v_exp_f32 v132, v132
    v_exp_f32 v16, v16
    v_exp_f32 v17, v17
    v_exp_f32 v18, v18
    v_exp_f32 v19, v19
    v_mov_b32 v14, v130
    v_mul_f32 v15, v15, v132
    v_mul_f32 v10, v10, v132
    v_mul_f32 v11, v11, v132
    v_mul_f32 v12, v12, v132
    v_mul_f32 v13, v13, v132
    v_cvt_pk_bf16_f32 v24, v16, v16
    v_cvt_pk_bf16_f32 v25, v17, v17
    v_cvt_pk_bf16_f32 v26, v18, v18
    v_cvt_pk_bf16_f32 v27, v19, v19
    v_add_f32 v15, v15, v16
    v_add_f32 v15, v15, v17
    v_add_f32 v15, v15, v18
    v_add_f32 v15, v15, v19
    v_and_b32 v122, v2, v24
    v_and_b32 v123, v3, v24
    v_and_b32 v124, v4, v24
    v_and_b32 v125, v5, v24
    s_waitcnt vmcnt(16)
    s_nop 0
    v_mfma_f32_16x16x32_bf16 v[10:13], v[188:191], v[122:125], v[10:13]
    v_and_b32 v126, v2, v25
    v_and_b32 v127, v3, v25
    v_and_b32 v128, v4, v25
    v_and_b32 v129, v5, v25
    s_waitcnt vmcnt(15)
    s_nop 0
    v_mfma_f32_16x16x32_bf16 v[10:13], v[192:195], v[126:129], v[10:13]
    v_and_b32 v122, v2, v26
    v_and_b32 v123, v3, v26
    v_and_b32 v124, v4, v26
    v_and_b32 v125, v5, v26
    s_waitcnt vmcnt(14)
    s_nop 0
    v_mfma_f32_16x16x32_bf16 v[10:13], v[196:199], v[122:125], v[10:13]
    v_and_b32 v126, v2, v27
    v_and_b32 v127, v3, v27
    v_and_b32 v128, v4, v27
    v_and_b32 v129, v5, v27
    s_waitcnt vmcnt(13)
    s_nop 0
    v_mfma_f32_16x16x32_bf16 v[10:13], v[200:203], v[126:129], v[10:13]
    s_mov_b32 s87, s99
    s_movk_i32 s89, 13
L_b_loop_5:
    s_add_u32 s99, s87, 4096
    s_waitcnt vmcnt(7)
    v_dot2_f32_bf16 v16, v40, v32, 0
    v_dot2_f32_bf16 v24, v40, v36, 0
    v_dot2_f32_bf16 v16, v41, v33, v16
    v_dot2_f32_bf16 v24, v41, v37, v24
    v_dot2_f32_bf16 v16, v42, v34, v16
    v_dot2_f32_bf16 v24, v42, v38, v24
    v_dot2_f32_bf16 v16, v43, v35, v16
    v_dot2_f32_bf16 v24, v43, v39, v24
    buffer_load_dwordx4 v[40:43], v6, s[56:59], s99 offen nt
    s_waitcnt vmcnt(7)
    v_dot2_f32_bf16 v17, v44, v32, 0
    v_dot2_f32_bf16 v25, v44, v36, 0
    v_dot2_f32_bf16 v17, v45, v33, v17
    v_dot2_f32_bf16 v25, v45, v37, v25
    v_dot2_f32_bf16 v17, v46, v34, v17
    v_dot2_f32_bf16 v25, v46, v38, v25
    v_dot2_f32_bf16 v17, v47, v35, v17
    v_dot2_f32_bf16 v25, v47, v39, v25
    buffer_load_dwordx4 v[44:47], v6, s[56:59], s99 offen offset:1024 nt
    s_waitcnt vmcnt(7)
    v_dot2_f32_bf16 v18, v48, v32, 0
    v_dot2_f32_bf16 v26, v48, v36, 0
    v_dot2_f32_bf16 v18, v49, v33, v18
    v_dot2_f32_bf16 v26, v49, v37, v26
    v_dot2_f32_bf16 v18, v50, v34, v18
    v_dot2_f32_bf16 v26, v50, v38, v26
    v_dot2_f32_bf16 v18, v51, v35, v18
    v_dot2_f32_bf16 v26, v51, v39, v26
    buffer_load_dwordx4 v[48:51], v6, s[56:59], s99 offen offset:2048 nt
    s_waitcnt vmcnt(7)
    v_dot2_f32_bf16 v19, v52, v32, 0
    v_dot2_f32_bf16 v27, v52, v36, 0
    v_dot2_f32_bf16 v19, v53, v33, v19
    v_dot2_f32_bf16 v27, v53, v37, v27
    v_dot2_f32_bf16 v19, v54, v34, v19
    v_dot2_f32_bf16 v27, v54, v38, v27
    v_dot2_f32_bf16 v19, v55, v35, v19
    v_dot2_f32_bf16 v27, v55, v39, v27
    buffer_load_dwordx4 v[52:55], v6, s[56:59], s99 offen offset:3072 nt
    v_add_f32_dpp v16, v24, v16 row_ror:8 row_mask:0xf bank_mask:0xf
    v_add_f32_dpp v17, v25, v17 row_ror:8 row_mask:0xf bank_mask:0xf
    v_add_f32_dpp v18, v26, v18 row_ror:8 row_mask:0xf bank_mask:0xf
    v_add_f32_dpp v19, v27, v19 row_ror:8 row_mask:0xf bank_mask:0xf
    v_add_f32_dpp v16, v16, v16 quad_perm:[1,0,3,2] row_mask:0xf bank_mask:0xf
    v_add_f32_dpp v17, v17, v17 quad_perm:[1,0,3,2] row_mask:0xf bank_mask:0xf
    v_add_f32_dpp v18, v18, v18 quad_perm:[1,0,3,2] row_mask:0xf bank_mask:0xf
    v_add_f32_dpp v19, v19, v19 quad_perm:[1,0,3,2] row_mask:0xf bank_mask:0xf
    v_add_f32_dpp v16, v16, v16 quad_perm:[2,3,0,1] row_mask:0xf bank_mask:0xf
    v_add_f32_dpp v17, v17, v17 quad_perm:[2,3,0,1] row_mask:0xf bank_mask:0xf
    v_add_f32_dpp v18, v18, v18 quad_perm:[2,3,0,1] row_mask:0xf bank_mask:0xf
    v_add_f32_dpp v19, v19, v19 quad_perm:[2,3,0,1] row_mask:0xf bank_mask:0xf
    v_add_f32_dpp v16, v16, v16 row_half_mirror row_mask:0xf bank_mask:0xf
    v_add_f32_dpp v17, v17, v17 row_half_mirror row_mask:0xf bank_mask:0xf
    v_add_f32_dpp v18, v18, v18 row_half_mirror row_mask:0xf bank_mask:0xf
    v_add_f32_dpp v19, v19, v19 row_half_mirror row_mask:0xf bank_mask:0xf
    v_max_f32 v130, v16, v17
    v_max3_f32 v130, v130, v18, v19
    v_mov_b32 v131, v130
    s_nop 1
    v_permlane16_swap_b32 v130, v131
    v_max_f32 v130, v130, v131
    v_mov_b32 v131, v130
    s_nop 1
    v_permlane32_swap_b32 v130, v131
    v_max_f32 v130, v130, v131
    v_max_f32 v130, v130, v14
    v_sub_f32 v132, v14, v130
    v_sub_f32 v16, v16, v130
    v_sub_f32 v17, v17, v130
    v_sub_f32 v18, v18, v130
    v_sub_f32 v19, v19, v130
    v_exp_f32 v132, v132
    v_exp_f32 v16, v16
    v_exp_f32 v17, v17
    v_exp_f32 v18, v18
    v_exp_f32 v19, v19
    v_mov_b32 v14, v130
    v_mul_f32 v15, v15, v132
    v_mul_f32 v10, v10, v132
    v_mul_f32 v11, v11, v132
    v_mul_f32 v12, v12, v132
    v_mul_f32 v13, v13, v132
    v_cvt_pk_bf16_f32 v24, v16, v16
    v_cvt_pk_bf16_f32 v25, v17, v17
    v_cvt_pk_bf16_f32 v26, v18, v18
    v_cvt_pk_bf16_f32 v27, v19, v19
    v_add_f32 v15, v15, v16
    v_add_f32 v15, v15, v17
    v_add_f32 v15, v15, v18
    v_add_f32 v15, v15, v19
    v_and_b32 v122, v2, v24
    v_and_b32 v123, v3, v24
    v_and_b32 v124, v4, v24
    v_and_b32 v125, v5, v24
    s_waitcnt vmcnt(7)
    s_nop 0
    v_mfma_f32_16x16x32_bf16 v[10:13], v[72:75], v[122:125], v[10:13]
    buffer_load_dwordx4 v[72:75], v6, s[60:63], s99 offen nt
    v_and_b32 v126, v2, v25
    v_and_b32 v127, v3, v25
    v_and_b32 v128, v4, v25
    v_and_b32 v129, v5, v25
    s_waitcnt vmcnt(7)
    s_nop 0
    v_mfma_f32_16x16x32_bf16 v[10:13], v[76:79], v[126:129], v[10:13]
    buffer_load_dwordx4 v[76:79], v6, s[60:63], s99 offen offset:1024 nt
    v_and_b32 v122, v2, v26
    v_and_b32 v123, v3, v26
    v_and_b32 v124, v4, v26
    v_and_b32 v125, v5, v26
    s_waitcnt vmcnt(7)
    s_nop 0
    v_mfma_f32_16x16x32_bf16 v[10:13], v[80:83], v[122:125], v[10:13]
    buffer_load_dwordx4 v[80:83], v6, s[60:63], s99 offen offset:2048 nt
    v_and_b32 v126, v2, v27
    v_and_b32 v127, v3, v27
    v_and_b32 v128, v4, v27
    v_and_b32 v129, v5, v27
    s_waitcnt vmcnt(7)
    s_nop 0
    v_mfma_f32_16x16x32_bf16 v[10:13], v[84:87], v[126:129], v[10:13]
    buffer_load_dwordx4 v[84:87], v6, s[60:63], s99 offen offset:3072 nt
    s_mov_b32 s87, s99
    s_sub_u32 s89, s89, 1
    s_cmp_lg_u32 s89, 0
    s_cbranch_scc1 L_b_loop_5
    v_dot2_f32_bf16 v220, v204, v212, 0
    v_dot2_f32_bf16 v220, v205, v213, v220
    v_dot2_f32_bf16 v220, v206, v214, v220
    v_dot2_f32_bf16 v220, v207, v215, v220
    v_dot2_f32_bf16 v220, v208, v216, v220
    v_dot2_f32_bf16 v220, v209, v217, v220
    v_dot2_f32_bf16 v220, v210, v218, v220
    v_dot2_f32_bf16 v220, v211, v219, v220
    s_nop 2
    v_add_f32_dpp v220, v220, v220 row_ror:8 row_mask:0xf bank_mask:0xf
    s_nop 1
    v_add_f32_dpp v220, v220, v220 quad_perm:[1,0,3,2] row_mask:0xf bank_mask:0xf
    s_nop 1
    v_add_f32_dpp v220, v220, v220 quad_perm:[2,3,0,1] row_mask:0xf bank_mask:0xf
    s_nop 1
    v_add_f32_dpp v220, v220, v220 row_half_mirror row_mask:0xf bank_mask:0xf
    v_mov_b32 v221, v220
    s_nop 1
    v_permlane16_swap_b32 v220, v221
    v_add_f32 v220, v220, v221
    v_mov_b32 v221, v220
    s_nop 1
    v_permlane32_swap_b32 v220, v221
    v_add_f32 v220, v220, v221
    v_mul_f32 v220, 0xbfb8aa3b, v220
    v_exp_f32 v220, v220
    s_nop 0
    v_add_f32 v220, 1.0, v220
    v_rcp_f32 v220, v220
L_b_dyn_6:
    s_waitcnt vmcnt(7)
    v_readfirstlane_b32 s99, v133
    s_add_u32 s99, s99, 48
    s_cmp_ge_u32 s99, 208
    s_cbranch_scc1 L_b_last_7
    s_cmp_ge_u32 s99, 184
    s_cbranch_scc1 L_b_fin_8
    v_mov_b32 v133, 1
    s_mov_b64 exec, 1
    buffer_atomic_add v133, v134, s[52:55], s20 offen sc0 sc1
    s_mov_b64 exec, -1
    s_add_u32 s99, s99, 816
    s_mul_i32 s99, s99, 4096
    s_waitcnt vmcnt(8)
    v_dot2_f32_bf16 v16, v40, v32, 0
    v_dot2_f32_bf16 v24, v40, v36, 0
    v_dot2_f32_bf16 v16, v41, v33, v16
    v_dot2_f32_bf16 v24, v41, v37, v24
    v_dot2_f32_bf16 v16, v42, v34, v16
    v_dot2_f32_bf16 v24, v42, v38, v24
    v_dot2_f32_bf16 v16, v43, v35, v16
    v_dot2_f32_bf16 v24, v43, v39, v24
    buffer_load_dwordx4 v[40:43], v6, s[56:59], s99 offen nt
    s_waitcnt vmcnt(8)
    v_dot2_f32_bf16 v17, v44, v32, 0
    v_dot2_f32_bf16 v25, v44, v36, 0
    v_dot2_f32_bf16 v17, v45, v33, v17
    v_dot2_f32_bf16 v25, v45, v37, v25
    v_dot2_f32_bf16 v17, v46, v34, v17
    v_dot2_f32_bf16 v25, v46, v38, v25
    v_dot2_f32_bf16 v17, v47, v35, v17
    v_dot2_f32_bf16 v25, v47, v39, v25
    buffer_load_dwordx4 v[44:47], v6, s[56:59], s99 offen offset:1024 nt
    s_waitcnt vmcnt(8)
    v_dot2_f32_bf16 v18, v48, v32, 0
    v_dot2_f32_bf16 v26, v48, v36, 0
    v_dot2_f32_bf16 v18, v49, v33, v18
    v_dot2_f32_bf16 v26, v49, v37, v26
    v_dot2_f32_bf16 v18, v50, v34, v18
    v_dot2_f32_bf16 v26, v50, v38, v26
    v_dot2_f32_bf16 v18, v51, v35, v18
    v_dot2_f32_bf16 v26, v51, v39, v26
    buffer_load_dwordx4 v[48:51], v6, s[56:59], s99 offen offset:2048 nt
    s_waitcnt vmcnt(8)
    v_dot2_f32_bf16 v19, v52, v32, 0
    v_dot2_f32_bf16 v27, v52, v36, 0
    v_dot2_f32_bf16 v19, v53, v33, v19
    v_dot2_f32_bf16 v27, v53, v37, v27
    v_dot2_f32_bf16 v19, v54, v34, v19
    v_dot2_f32_bf16 v27, v54, v38, v27
    v_dot2_f32_bf16 v19, v55, v35, v19
    v_dot2_f32_bf16 v27, v55, v39, v27
    buffer_load_dwordx4 v[52:55], v6, s[56:59], s99 offen offset:3072 nt
    v_add_f32_dpp v16, v24, v16 row_ror:8 row_mask:0xf bank_mask:0xf
    v_add_f32_dpp v17, v25, v17 row_ror:8 row_mask:0xf bank_mask:0xf
    v_add_f32_dpp v18, v26, v18 row_ror:8 row_mask:0xf bank_mask:0xf
    v_add_f32_dpp v19, v27, v19 row_ror:8 row_mask:0xf bank_mask:0xf
    v_add_f32_dpp v16, v16, v16 quad_perm:[1,0,3,2] row_mask:0xf bank_mask:0xf
    v_add_f32_dpp v17, v17, v17 quad_perm:[1,0,3,2] row_mask:0xf bank_mask:0xf
    v_add_f32_dpp v18, v18, v18 quad_perm:[1,0,3,2] row_mask:0xf bank_mask:0xf
    v_add_f32_dpp v19, v19, v19 quad_perm:[1,0,3,2] row_mask:0xf bank_mask:0xf
    v_add_f32_dpp v16, v16, v16 quad_perm:[2,3,0,1] row_mask:0xf bank_mask:0xf
    v_add_f32_dpp v17, v17, v17 quad_perm:[2,3,0,1] row_mask:0xf bank_mask:0xf
    v_add_f32_dpp v18, v18, v18 quad_perm:[2,3,0,1] row_mask:0xf bank_mask:0xf
    v_add_f32_dpp v19, v19, v19 quad_perm:[2,3,0,1] row_mask:0xf bank_mask:0xf
    v_add_f32_dpp v16, v16, v16 row_half_mirror row_mask:0xf bank_mask:0xf
    v_add_f32_dpp v17, v17, v17 row_half_mirror row_mask:0xf bank_mask:0xf
    v_add_f32_dpp v18, v18, v18 row_half_mirror row_mask:0xf bank_mask:0xf
    v_add_f32_dpp v19, v19, v19 row_half_mirror row_mask:0xf bank_mask:0xf
    v_max_f32 v130, v16, v17
    v_max3_f32 v130, v130, v18, v19
    v_mov_b32 v131, v130
    s_nop 1
    v_permlane16_swap_b32 v130, v131
    v_max_f32 v130, v130, v131
    v_mov_b32 v131, v130
    s_nop 1
    v_permlane32_swap_b32 v130, v131
    v_max_f32 v130, v130, v131
    v_max_f32 v130, v130, v14
    v_sub_f32 v132, v14, v130
    v_sub_f32 v16, v16, v130
    v_sub_f32 v17, v17, v130
    v_sub_f32 v18, v18, v130
    v_sub_f32 v19, v19, v130
    v_exp_f32 v132, v132
    v_exp_f32 v16, v16
    v_exp_f32 v17, v17
    v_exp_f32 v18, v18
    v_exp_f32 v19, v19
    v_mov_b32 v14, v130
    v_mul_f32 v15, v15, v132
    v_mul_f32 v10, v10, v132
    v_mul_f32 v11, v11, v132
    v_mul_f32 v12, v12, v132
    v_mul_f32 v13, v13, v132
    v_cvt_pk_bf16_f32 v24, v16, v16
    v_cvt_pk_bf16_f32 v25, v17, v17
    v_cvt_pk_bf16_f32 v26, v18, v18
    v_cvt_pk_bf16_f32 v27, v19, v19
    v_add_f32 v15, v15, v16
    v_add_f32 v15, v15, v17
    v_add_f32 v15, v15, v18
    v_add_f32 v15, v15, v19
    v_and_b32 v122, v2, v24
    v_and_b32 v123, v3, v24
    v_and_b32 v124, v4, v24
    v_and_b32 v125, v5, v24
    s_waitcnt vmcnt(8)
    s_nop 0
    v_mfma_f32_16x16x32_bf16 v[10:13], v[72:75], v[122:125], v[10:13]
    buffer_load_dwordx4 v[72:75], v6, s[60:63], s99 offen nt
    v_and_b32 v126, v2, v25
    v_and_b32 v127, v3, v25
    v_and_b32 v128, v4, v25
    v_and_b32 v129, v5, v25
    s_waitcnt vmcnt(8)
    s_nop 0
    v_mfma_f32_16x16x32_bf16 v[10:13], v[76:79], v[126:129], v[10:13]
    buffer_load_dwordx4 v[76:79], v6, s[60:63], s99 offen offset:1024 nt
    v_and_b32 v122, v2, v26
    v_and_b32 v123, v3, v26
    v_and_b32 v124, v4, v26
    v_and_b32 v125, v5, v26
    s_waitcnt vmcnt(8)
    s_nop 0
    v_mfma_f32_16x16x32_bf16 v[10:13], v[80:83], v[122:125], v[10:13]
    buffer_load_dwordx4 v[80:83], v6, s[60:63], s99 offen offset:2048 nt
    v_and_b32 v126, v2, v27
    v_and_b32 v127, v3, v27
    v_and_b32 v128, v4, v27
    v_and_b32 v129, v5, v27
    s_waitcnt vmcnt(8)
    s_nop 0
    v_mfma_f32_16x16x32_bf16 v[10:13], v[84:87], v[126:129], v[10:13]
    buffer_load_dwordx4 v[84:87], v6, s[60:63], s99 offen offset:3072 nt
    s_branch L_b_dyn_6
L_b_fin_8:
    s_add_u32 s99, s99, 816
    s_mul_i32 s99, s99, 4096
    s_waitcnt vmcnt(7)
    v_dot2_f32_bf16 v16, v40, v32, 0
    v_dot2_f32_bf16 v24, v40, v36, 0
    v_dot2_f32_bf16 v16, v41, v33, v16
    v_dot2_f32_bf16 v24, v41, v37, v24
    v_dot2_f32_bf16 v16, v42, v34, v16
    v_dot2_f32_bf16 v24, v42, v38, v24
    v_dot2_f32_bf16 v16, v43, v35, v16
    v_dot2_f32_bf16 v24, v43, v39, v24
    buffer_load_dwordx4 v[40:43], v6, s[56:59], s99 offen nt
    s_waitcnt vmcnt(7)
    v_dot2_f32_bf16 v17, v44, v32, 0
    v_dot2_f32_bf16 v25, v44, v36, 0
    v_dot2_f32_bf16 v17, v45, v33, v17
    v_dot2_f32_bf16 v25, v45, v37, v25
    v_dot2_f32_bf16 v17, v46, v34, v17
    v_dot2_f32_bf16 v25, v46, v38, v25
    v_dot2_f32_bf16 v17, v47, v35, v17
    v_dot2_f32_bf16 v25, v47, v39, v25
    buffer_load_dwordx4 v[44:47], v6, s[56:59], s99 offen offset:1024 nt
    s_waitcnt vmcnt(7)
    v_dot2_f32_bf16 v18, v48, v32, 0
    v_dot2_f32_bf16 v26, v48, v36, 0
    v_dot2_f32_bf16 v18, v49, v33, v18
    v_dot2_f32_bf16 v26, v49, v37, v26
    v_dot2_f32_bf16 v18, v50, v34, v18
    v_dot2_f32_bf16 v26, v50, v38, v26
    v_dot2_f32_bf16 v18, v51, v35, v18
    v_dot2_f32_bf16 v26, v51, v39, v26
    buffer_load_dwordx4 v[48:51], v6, s[56:59], s99 offen offset:2048 nt
    s_waitcnt vmcnt(7)
    v_dot2_f32_bf16 v19, v52, v32, 0
    v_dot2_f32_bf16 v27, v52, v36, 0
    v_dot2_f32_bf16 v19, v53, v33, v19
    v_dot2_f32_bf16 v27, v53, v37, v27
    v_dot2_f32_bf16 v19, v54, v34, v19
    v_dot2_f32_bf16 v27, v54, v38, v27
    v_dot2_f32_bf16 v19, v55, v35, v19
    v_dot2_f32_bf16 v27, v55, v39, v27
    buffer_load_dwordx4 v[52:55], v6, s[56:59], s99 offen offset:3072 nt
    v_add_f32_dpp v16, v24, v16 row_ror:8 row_mask:0xf bank_mask:0xf
    v_add_f32_dpp v17, v25, v17 row_ror:8 row_mask:0xf bank_mask:0xf
    v_add_f32_dpp v18, v26, v18 row_ror:8 row_mask:0xf bank_mask:0xf
    v_add_f32_dpp v19, v27, v19 row_ror:8 row_mask:0xf bank_mask:0xf
    v_add_f32_dpp v16, v16, v16 quad_perm:[1,0,3,2] row_mask:0xf bank_mask:0xf
    v_add_f32_dpp v17, v17, v17 quad_perm:[1,0,3,2] row_mask:0xf bank_mask:0xf
    v_add_f32_dpp v18, v18, v18 quad_perm:[1,0,3,2] row_mask:0xf bank_mask:0xf
    v_add_f32_dpp v19, v19, v19 quad_perm:[1,0,3,2] row_mask:0xf bank_mask:0xf
    v_add_f32_dpp v16, v16, v16 quad_perm:[2,3,0,1] row_mask:0xf bank_mask:0xf
    v_add_f32_dpp v17, v17, v17 quad_perm:[2,3,0,1] row_mask:0xf bank_mask:0xf
    v_add_f32_dpp v18, v18, v18 quad_perm:[2,3,0,1] row_mask:0xf bank_mask:0xf
    v_add_f32_dpp v19, v19, v19 quad_perm:[2,3,0,1] row_mask:0xf bank_mask:0xf
    v_add_f32_dpp v16, v16, v16 row_half_mirror row_mask:0xf bank_mask:0xf
    v_add_f32_dpp v17, v17, v17 row_half_mirror row_mask:0xf bank_mask:0xf
    v_add_f32_dpp v18, v18, v18 row_half_mirror row_mask:0xf bank_mask:0xf
    v_add_f32_dpp v19, v19, v19 row_half_mirror row_mask:0xf bank_mask:0xf
    v_max_f32 v130, v16, v17
    v_max3_f32 v130, v130, v18, v19
    v_mov_b32 v131, v130
    s_nop 1
    v_permlane16_swap_b32 v130, v131
    v_max_f32 v130, v130, v131
    v_mov_b32 v131, v130
    s_nop 1
    v_permlane32_swap_b32 v130, v131
    v_max_f32 v130, v130, v131
    v_max_f32 v130, v130, v14
    v_sub_f32 v132, v14, v130
    v_sub_f32 v16, v16, v130
    v_sub_f32 v17, v17, v130
    v_sub_f32 v18, v18, v130
    v_sub_f32 v19, v19, v130
    v_exp_f32 v132, v132
    v_exp_f32 v16, v16
    v_exp_f32 v17, v17
    v_exp_f32 v18, v18
    v_exp_f32 v19, v19
    v_mov_b32 v14, v130
    v_mul_f32 v15, v15, v132
    v_mul_f32 v10, v10, v132
    v_mul_f32 v11, v11, v132
    v_mul_f32 v12, v12, v132
    v_mul_f32 v13, v13, v132
    v_cvt_pk_bf16_f32 v24, v16, v16
    v_cvt_pk_bf16_f32 v25, v17, v17
    v_cvt_pk_bf16_f32 v26, v18, v18
    v_cvt_pk_bf16_f32 v27, v19, v19
    v_add_f32 v15, v15, v16
    v_add_f32 v15, v15, v17
    v_add_f32 v15, v15, v18
    v_add_f32 v15, v15, v19
    v_and_b32 v122, v2, v24
    v_and_b32 v123, v3, v24
    v_and_b32 v124, v4, v24
    v_and_b32 v125, v5, v24
    s_waitcnt vmcnt(7)
    s_nop 0
    v_mfma_f32_16x16x32_bf16 v[10:13], v[72:75], v[122:125], v[10:13]
    buffer_load_dwordx4 v[72:75], v6, s[60:63], s99 offen nt
    v_and_b32 v126, v2, v25
    v_and_b32 v127, v3, v25
    v_and_b32 v128, v4, v25
    v_and_b32 v129, v5, v25
    s_waitcnt vmcnt(7)
    s_nop 0
    v_mfma_f32_16x16x32_bf16 v[10:13], v[76:79], v[126:129], v[10:13]
    buffer_load_dwordx4 v[76:79], v6, s[60:63], s99 offen offset:1024 nt
    v_and_b32 v122, v2, v26
    v_and_b32 v123, v3, v26
    v_and_b32 v124, v4, v26
    v_and_b32 v125, v5, v26
    s_waitcnt vmcnt(7)
    s_nop 0
    v_mfma_f32_16x16x32_bf16 v[10:13], v[80:83], v[122:125], v[10:13]
    buffer_load_dwordx4 v[80:83], v6, s[60:63], s99 offen offset:2048 nt
    v_and_b32 v126, v2, v27
    v_and_b32 v127, v3, v27
    v_and_b32 v128, v4, v27
    v_and_b32 v129, v5, v27
    s_waitcnt vmcnt(7)
    s_nop 0
    v_mfma_f32_16x16x32_bf16 v[10:13], v[84:87], v[126:129], v[10:13]
    buffer_load_dwordx4 v[84:87], v6, s[60:63], s99 offen offset:3072 nt
L_b_last_7:
    s_waitcnt vmcnt(7)
    v_dot2_f32_bf16 v16, v40, v32, 0
    v_dot2_f32_bf16 v24, v40, v36, 0
    v_dot2_f32_bf16 v16, v41, v33, v16
    v_dot2_f32_bf16 v24, v41, v37, v24
    v_dot2_f32_bf16 v16, v42, v34, v16
    v_dot2_f32_bf16 v24, v42, v38, v24
    v_dot2_f32_bf16 v16, v43, v35, v16
    v_dot2_f32_bf16 v24, v43, v39, v24
    buffer_load_dwordx4 v[140:143], v250, s[72:75], s93 offen nt
    s_add_u32 s93, s93, 9216
    s_waitcnt vmcnt(7)
    v_dot2_f32_bf16 v17, v44, v32, 0
    v_dot2_f32_bf16 v25, v44, v36, 0
    v_dot2_f32_bf16 v17, v45, v33, v17
    v_dot2_f32_bf16 v25, v45, v37, v25
    v_dot2_f32_bf16 v17, v46, v34, v17
    v_dot2_f32_bf16 v25, v46, v38, v25
    v_dot2_f32_bf16 v17, v47, v35, v17
    v_dot2_f32_bf16 v25, v47, v39, v25
    buffer_load_dwordx4 v[144:147], v250, s[72:75], s93 offen nt
    s_add_u32 s93, s93, 9216
    s_waitcnt vmcnt(7)
    v_dot2_f32_bf16 v18, v48, v32, 0
    v_dot2_f32_bf16 v26, v48, v36, 0
    v_dot2_f32_bf16 v18, v49, v33, v18
    v_dot2_f32_bf16 v26, v49, v37, v26
    v_dot2_f32_bf16 v18, v50, v34, v18
    v_dot2_f32_bf16 v26, v50, v38, v26
    v_dot2_f32_bf16 v18, v51, v35, v18
    v_dot2_f32_bf16 v26, v51, v39, v26
    buffer_load_dwordx4 v[148:151], v250, s[72:75], s93 offen nt
    s_add_u32 s93, s93, 9216
    s_waitcnt vmcnt(7)
    v_dot2_f32_bf16 v19, v52, v32, 0
    v_dot2_f32_bf16 v27, v52, v36, 0
    v_dot2_f32_bf16 v19, v53, v33, v19
    v_dot2_f32_bf16 v27, v53, v37, v27
    v_dot2_f32_bf16 v19, v54, v34, v19
    v_dot2_f32_bf16 v27, v54, v38, v27
    v_dot2_f32_bf16 v19, v55, v35, v19
    v_dot2_f32_bf16 v27, v55, v39, v27
    buffer_load_dwordx4 v[152:155], v250, s[72:75], s93 offen nt
    s_add_u32 s93, s93, 9216
    v_add_f32_dpp v16, v24, v16 row_ror:8 row_mask:0xf bank_mask:0xf
    v_add_f32_dpp v17, v25, v17 row_ror:8 row_mask:0xf bank_mask:0xf
    v_add_f32_dpp v18, v26, v18 row_ror:8 row_mask:0xf bank_mask:0xf
    v_add_f32_dpp v19, v27, v19 row_ror:8 row_mask:0xf bank_mask:0xf
    v_add_f32_dpp v16, v16, v16 quad_perm:[1,0,3,2] row_mask:0xf bank_mask:0xf
    v_add_f32_dpp v17, v17, v17 quad_perm:[1,0,3,2] row_mask:0xf bank_mask:0xf
    v_add_f32_dpp v18, v18, v18 quad_perm:[1,0,3,2] row_mask:0xf bank_mask:0xf
    v_add_f32_dpp v19, v19, v19 quad_perm:[1,0,3,2] row_mask:0xf bank_mask:0xf
    v_add_f32_dpp v16, v16, v16 quad_perm:[2,3,0,1] row_mask:0xf bank_mask:0xf
    v_add_f32_dpp v17, v17, v17 quad_perm:[2,3,0,1] row_mask:0xf bank_mask:0xf
    v_add_f32_dpp v18, v18, v18 quad_perm:[2,3,0,1] row_mask:0xf bank_mask:0xf
    v_add_f32_dpp v19, v19, v19 quad_perm:[2,3,0,1] row_mask:0xf bank_mask:0xf
    v_add_f32_dpp v16, v16, v16 row_half_mirror row_mask:0xf bank_mask:0xf
    v_add_f32_dpp v17, v17, v17 row_half_mirror row_mask:0xf bank_mask:0xf
    v_add_f32_dpp v18, v18, v18 row_half_mirror row_mask:0xf bank_mask:0xf
    v_add_f32_dpp v19, v19, v19 row_half_mirror row_mask:0xf bank_mask:0xf
    v_max_f32 v130, v16, v17
    v_max3_f32 v130, v130, v18, v19
    v_mov_b32 v131, v130
    s_nop 1
    v_permlane16_swap_b32 v130, v131
    v_max_f32 v130, v130, v131
    v_mov_b32 v131, v130
    s_nop 1
    v_permlane32_swap_b32 v130, v131
    v_max_f32 v130, v130, v131
    v_max_f32 v130, v130, v14
    v_sub_f32 v132, v14, v130
    v_sub_f32 v16, v16, v130
    v_sub_f32 v17, v17, v130
    v_sub_f32 v18, v18, v130
    v_sub_f32 v19, v19, v130
    v_exp_f32 v132, v132
    v_exp_f32 v16, v16
    v_exp_f32 v17, v17
    v_exp_f32 v18, v18
    v_exp_f32 v19, v19
    v_mov_b32 v14, v130
    v_mul_f32 v15, v15, v132
    v_mul_f32 v10, v10, v132
    v_mul_f32 v11, v11, v132
    v_mul_f32 v12, v12, v132
    v_mul_f32 v13, v13, v132
    v_cvt_pk_bf16_f32 v24, v16, v16
    v_cvt_pk_bf16_f32 v25, v17, v17
    v_cvt_pk_bf16_f32 v26, v18, v18
    v_cvt_pk_bf16_f32 v27, v19, v19
    v_add_f32 v15, v15, v16
    v_add_f32 v15, v15, v17
    v_add_f32 v15, v15, v18
    v_add_f32 v15, v15, v19
    v_and_b32 v122, v2, v24
    v_and_b32 v123, v3, v24
    v_and_b32 v124, v4, v24
    v_and_b32 v125, v5, v24
    s_waitcnt vmcnt(7)
    s_nop 0
    v_mfma_f32_16x16x32_bf16 v[10:13], v[72:75], v[122:125], v[10:13]
    buffer_load_dwordx4 v[156:159], v250, s[72:75], s93 offen nt
    s_add_u32 s93, s93, 9216
    v_and_b32 v126, v2, v25
    v_and_b32 v127, v3, v25
    v_and_b32 v128, v4, v25
    v_and_b32 v129, v5, v25
    s_waitcnt vmcnt(7)
    s_nop 0
    v_mfma_f32_16x16x32_bf16 v[10:13], v[76:79], v[126:129], v[10:13]
    buffer_load_dwordx4 v[160:163], v250, s[72:75], s93 offen nt
    s_add_u32 s93, s93, 9216
    v_and_b32 v122, v2, v26
    v_and_b32 v123, v3, v26
    v_and_b32 v124, v4, v26
    v_and_b32 v125, v5, v26
    s_waitcnt vmcnt(7)
    s_nop 0
    v_mfma_f32_16x16x32_bf16 v[10:13], v[80:83], v[122:125], v[10:13]
    buffer_load_dwordx4 v[164:167], v250, s[72:75], s93 offen nt
    s_add_u32 s93, s93, 9216
    v_and_b32 v126, v2, v27
    v_and_b32 v127, v3, v27
    v_and_b32 v128, v4, v27
    v_and_b32 v129, v5, v27
    s_waitcnt vmcnt(7)
    s_nop 0
    v_mfma_f32_16x16x32_bf16 v[10:13], v[84:87], v[126:129], v[10:13]
    buffer_load_dwordx4 v[168:171], v250, s[72:75], s93 offen nt
    s_add_u32 s93, s93, 9216
    v_mov_b32 v130, v15
    s_nop 1
    v_permlane16_swap_b32 v15, v130
    v_add_f32 v15, v15, v130
    v_mov_b32 v130, v15
    s_nop 1
    v_permlane32_swap_b32 v15, v130
    v_add_f32 v15, v15, v130
    v_bfe_u32 v7, v1, 3, 1
    v_lshlrev_b32 v9, 5, v7
    v_lshlrev_b32 v7, 11, v7
    v_lshrrev_b32 v8, 4, v1
    v_lshlrev_b32 v8, 9, v8
    v_add_u32 v7, v7, v8
    v_and_b32 v8, 7, v1
    v_lshlrev_b32 v8, 4, v8
    s_lshl_b32 s6, s4, 2
    s_add_u32 s7, s6, 147456
    v_add3_u32 v7, v7, v8, s7
    s_add_u32 s7, s6, 151552
    v_add_u32 v9, s7, v9
    ds_write_b32 v7, v10 offset:0
    ds_write_b32 v7, v11 offset:128
    ds_write_b32 v7, v12 offset:256
    ds_write_b32 v7, v13 offset:384
    ds_write_b32 v9, v14
    ds_write_b32 v9, v15 offset:16
    s_waitcnt lgkmcnt(0)
    s_barrier
    s_cmp_ge_u32 s4, 2
    s_cbranch_scc1 L_b_pub_9
    s_lshl_b32 s6, s4, 11
    s_add_u32 s6, s6, 147456
    v_lshlrev_b32 v7, 5, v1
    v_add_u32 v7, s6, v7
    s_lshl_b32 s6, s4, 5
    s_add_u32 s6, s6, 151552
    v_mov_b32 v8, s6
    ds_read_b128 v[40:43], v8
    ds_read_b128 v[44:47], v8 offset:16
    ds_read_b128 v[48:51], v7
    ds_read_b128 v[52:55], v7 offset:16
    s_lshl_b32 s6, s86, 10
    s_lshl_b32 s7, s4, 9
    s_add_u32 s6, s6, s7
    s_add_u32 s6, s6, 0x60000
    s_lshl_b32 s7, s86, 1
    s_add_u32 s7, s7, s4
    s_lshl_b32 s7, s7, 7
    s_add_u32 s7, s7, 0xd0000
    s_waitcnt lgkmcnt(2)
    v_max3_f32 v56, v40, v41, v42
    v_max_f32 v56, v56, v43
    v_sub_f32 v40, v40, v56
    v_sub_f32 v41, v41, v56
    v_sub_f32 v42, v42, v56
    v_sub_f32 v43, v43, v56
    v_exp_f32 v40, v40
    v_exp_f32 v41, v41
    v_exp_f32 v42, v42
    v_exp_f32 v43, v43
    v_mul_f32 v57, v40, v44
    v_fmac_f32 v57, v41, v45
    v_fmac_f32 v57, v42, v46
    v_fmac_f32 v57, v43, v47
    s_waitcnt lgkmcnt(0)
    v_mul_f32 v58, v40, v48
    v_mul_f32 v60, v40, v52
    v_fmac_f32 v58, v41, v49
    v_fmac_f32 v60, v41, v53
    v_fmac_f32 v58, v42, v50
    v_fmac_f32 v60, v42, v54
    v_fmac_f32 v58, v43, v51
    v_fmac_f32 v60, v43, v55
    v_rcp_f32 v62, v57
    v_log_f32 v63, v57
    v_mov_b32 v59, s5
    v_mov_b32 v61, s5
    v_mul_f32 v58, v58, v62
    v_mul_f32 v60, v60, v62
    v_add_f32 v64, v56, v63
    v_mov_b32 v65, s5
    v_cvt_pk_bf16_f32 v58, v58, v60
    v_lshlrev_b32 v8, 3, v1
    buffer_store_dwordx2 v[58:59], v8, s[52:55], s6 offen sc0 sc1
    v_mov_b32 v7, 0
    s_mov_b64 exec, 1
    buffer_store_dwordx2 v[64:65], v7, s[52:55], s7 offen sc0 sc1
    s_mov_b64 exec, -1
L_b_pub_9:
    s_cmp_lt_u32 s85, 9
    s_cbranch_scc1 L_tail
    s_cmp_lg_u32 s85, 9
    s_cbranch_scc1 L_done
    s_cmp_ge_u32 s84, 9
    s_cbranch_scc1 L_done
    s_cmp_lg_u32 s4, 0
    s_cbranch_scc1 L_done
    s_lshl_b32 s6, s84, 13
    s_add_u32 s91, s6, 0xe0000
    v_and_b32 v7, 31, v1
    v_lshlrev_b32 v7, 4, v7
    v_lshrrev_b32 v8, 5, v1
    v_lshlrev_b32 v8, 9, v8
    v_add_u32 v7, v7, v8
    s_mov_b32 s80, s32
    s_mov_b32 s81, s33
    s_mov_b32 s82, 1152
    s_mov_b32 s83, 0x20000
    s_movk_i32 s88, 0x2000
L_x5_retry_10:
    buffer_load_dwordx4 v[40:43], v7, s[52:55], s91 offen offset:0 sc1
    buffer_load_dwordx4 v[44:47], v7, s[52:55], s91 offen offset:1024 sc1
    buffer_load_dwordx4 v[48:51], v7, s[52:55], s91 offen offset:2048 sc1
    buffer_load_dwordx4 v[52:55], v7, s[52:55], s91 offen offset:3072 sc1
    s_add_u32 s7, s91, 4096
    buffer_load_dwordx4 v[56:59], v7, s[52:55], s7 offen offset:0 sc1
    buffer_load_dwordx4 v[60:63], v7, s[52:55], s7 offen offset:1024 sc1
    buffer_load_dwordx4 v[64:67], v7, s[52:55], s7 offen offset:2048 sc1
    buffer_load_dwordx4 v[68:71], v7, s[52:55], s7 offen offset:3072 sc1
    s_waitcnt vmcnt(0)
    v_xor_b32 v72, s5, v41
    v_bitop3_b32 v72, v72, v43, s5 bitop3:0xf6
    v_bitop3_b32 v72, v72, v45, s5 bitop3:0xf6
    v_bitop3_b32 v72, v72, v47, s5 bitop3:0xf6
    v_bitop3_b32 v72, v72, v49, s5 bitop3:0xf6
    v_bitop3_b32 v72, v72, v51, s5 bitop3:0xf6
    v_bitop3_b32 v72, v72, v53, s5 bitop3:0xf6
    v_bitop3_b32 v72, v72, v55, s5 bitop3:0xf6
    v_bitop3_b32 v72, v72, v57, s5 bitop3:0xf6
    v_bitop3_b32 v72, v72, v59, s5 bitop3:0xf6
    v_bitop3_b32 v72, v72, v61, s5 bitop3:0xf6
    v_bitop3_b32 v72, v72, v63, s5 bitop3:0xf6
    v_bitop3_b32 v72, v72, v65, s5 bitop3:0xf6
    v_bitop3_b32 v72, v72, v67, s5 bitop3:0xf6
    v_bitop3_b32 v72, v72, v69, s5 bitop3:0xf6
    v_bitop3_b32 v72, v72, v71, s5 bitop3:0xf6
    v_cmp_ne_u32 vcc, 0, v72
    s_cbranch_vccz L_x5_ok_11
    s_sub_u32 s88, s88, 1
    s_cbranch_scc0 L_x5_retry_10
L_x5_ok_11:
    v_add_f32 v40, v40, v44
    v_add_f32 v48, v48, v52
    v_add_f32 v56, v56, v60
    v_add_f32 v64, v64, v68
    v_add_f32 v42, v42, v46
    v_add_f32 v50, v50, v54
    v_add_f32 v58, v58, v62
    v_add_f32 v66, v66, v70
    v_add_f32 v40, v40, v48
    v_add_f32 v56, v56, v64
    v_add_f32 v42, v42, v50
    v_add_f32 v58, v58, v66
    v_add_f32 v40, v40, v56
    v_add_f32 v42, v42, v58
    v_mov_b32 v44, v40
    v_mov_b32 v45, v42
    s_nop 0
    v_permlane32_swap_b32 v40, v44
    v_permlane32_swap_b32 v42, v45
    v_add_f32 v40, v40, v44
    v_add_f32 v42, v42, v45
    v_cvt_pk_bf16_f32 v40, v40, v42
    v_lshlrev_b32 v7, 2, v1
    s_lshl_b32 s6, s84, 7
    s_mov_b32 exec_hi, 0
    buffer_store_dword v40, v7, s[80:83], s6 offen
    s_cmp_lg_u32 s84, 0
    s_cbranch_scc1 L_fin_12
    v_mov_b32 v41, s5
    v_mov_b32 v7, 0
    s_mov_b64 exec, 1
    buffer_store_dword v41, v7, s[52:55], 0 offen sc0 sc1
L_fin_12:
    s_mov_b64 exec, -1
L_done:
    s_endpgm
L_tail:
    buffer_load_dwordx4 v[172:175], v250, s[72:75], s93 offen nt
    s_add_u32 s93, s93, 9216
    buffer_load_dwordx4 v[176:179], v250, s[72:75], s93 offen nt
    s_add_u32 s93, s93, 9216
    buffer_load_dwordx4 v[180:183], v250, s[72:75], s93 offen nt
    s_add_u32 s93, s93, 9216
    buffer_load_dwordx4 v[184:187], v250, s[72:75], s93 offen nt
    s_add_u32 s93, s93, 9216
    buffer_load_dwordx4 v[188:191], v250, s[72:75], s93 offen nt
    s_add_u32 s93, s93, 9216
    buffer_load_dwordx4 v[192:195], v250, s[72:75], s93 offen nt
    s_add_u32 s93, s93, 9216
    buffer_load_dwordx4 v[196:199], v250, s[72:75], s93 offen nt
    s_add_u32 s93, s93, 9216
    buffer_load_dwordx4 v[200:203], v250, s[72:75], s93 offen nt
    s_and_b32 s92, s4, 1
    s_cmp_ge_u32 s4, 2
    s_cbranch_scc1 L_t_a_13
    v_sub_f32 v220, 1.0, v220
    s_mul_i32 s91, s84, 12288
    s_lshl_b32 s6, s92, 9
    s_add_u32 s91, s91, s6
    s_add_u32 s91, s91, 0x60000
    s_mul_i32 s99, s84, 3072
    s_lshl_b32 s6, s92, 7
    s_add_u32 s99, s99, s6
    s_add_u32 s99, s99, 0xd0000
    v_and_b32 v8, 15, v1
    v_min_u32 v8, 5, v8
    v_lshlrev_b32 v8, 9, v8
    v_lshrrev_b32 v7, 5, v1
    v_lshl_add_u32 v8, v7, 8, v8
    v_and_b32 v9, 31, v1
    v_lshlrev_b32 v9, 4, v9
    v_lshl_add_u32 v7, v7, 10, v9
    s_movk_i32 s88, 0x2000
L_x4c_retry_16:
    buffer_load_dwordx2 v[96:97], v8, s[52:55], s99 offen sc1
    s_mov_b32 s7, s91
    buffer_load_dwordx4 v[40:43], v7, s[52:55], s7 offen sc1
    buffer_load_dwordx4 v[44:47], v7, s[52:55], s7 offen offset:2048 sc1
    s_add_u32 s7, s7, 4096
    buffer_load_dwordx4 v[48:51], v7, s[52:55], s7 offen sc1
    buffer_load_dwordx4 v[52:55], v7, s[52:55], s7 offen offset:2048 sc1
    s_add_u32 s7, s7, 4096
    buffer_load_dwordx4 v[56:59], v7, s[52:55], s7 offen sc1
    buffer_load_dwordx4 v[60:63], v7, s[52:55], s7 offen offset:2048 sc1
    s_waitcnt vmcnt(0)
    v_xor_b32 v98, s5, v97
    v_bitop3_b32 v98, v98, v41, s5 bitop3:0xf6
    v_bitop3_b32 v98, v98, v43, s5 bitop3:0xf6
    v_bitop3_b32 v98, v98, v45, s5 bitop3:0xf6
    v_bitop3_b32 v98, v98, v47, s5 bitop3:0xf6
    v_bitop3_b32 v98, v98, v49, s5 bitop3:0xf6
    v_bitop3_b32 v98, v98, v51, s5 bitop3:0xf6
    v_bitop3_b32 v98, v98, v53, s5 bitop3:0xf6
    v_bitop3_b32 v98, v98, v55, s5 bitop3:0xf6
    v_bitop3_b32 v98, v98, v57, s5 bitop3:0xf6
    v_bitop3_b32 v98, v98, v59, s5 bitop3:0xf6
    v_bitop3_b32 v98, v98, v61, s5 bitop3:0xf6
    v_bitop3_b32 v98, v98, v63, s5 bitop3:0xf6
    v_cmp_ne_u32 vcc, 0, v98
    s_cbranch_vccz L_x4c_ok_17
    s_sub_u32 s88, s88, 1
    s_cbranch_scc0 L_x4c_retry_16
L_x4c_ok_17:
    v_mov_b32 v98, v96
    s_nop 1
    v_max_f32_dpp v98, v98, v98 row_ror:8 row_mask:0xf bank_mask:0xf
    s_nop 1
    v_max_f32_dpp v98, v98, v98 quad_perm:[1,0,3,2] row_mask:0xf bank_mask:0xf
    s_nop 1
    v_max_f32_dpp v98, v98, v98 quad_perm:[2,3,0,1] row_mask:0xf bank_mask:0xf
    s_nop 1
    v_max_f32_dpp v98, v98, v98 row_half_mirror row_mask:0xf bank_mask:0xf
    v_mov_b32 v99, v98
    s_nop 1
    v_permlane32_swap_b32 v98, v99
    v_max_f32 v98, v98, v99
    v_sub_f32 v96, v96, v98
    v_exp_f32 v96, v96
    s_mov_b32 s96, 0x3f003f
    s_mov_b32 s97, 0x3f003f
    v_cndmask_b32 v96, 0, v96, s[96:97]
    v_mov_b32 v98, v96
    s_nop 1
    v_add_f32_dpp v98, v98, v98 row_ror:8 row_mask:0xf bank_mask:0xf
    s_nop 1
    v_add_f32_dpp v98, v98, v98 quad_perm:[1,0,3,2] row_mask:0xf bank_mask:0xf
    s_nop 1
    v_add_f32_dpp v98, v98, v98 quad_perm:[2,3,0,1] row_mask:0xf bank_mask:0xf
    s_nop 1
    v_add_f32_dpp v98, v98, v98 row_half_mirror row_mask:0xf bank_mask:0xf
    v_mov_b32 v99, v98
    s_nop 1
    v_permlane32_swap_b32 v98, v99
    v_add_f32 v98, v98, v99
    v_rcp_f32 v98, v98
    v_and_b32 v41, 0xffff0000, v40
    v_lshlrev_b32 v40, 16, v40
    v_and_b32 v43, 0xffff0000, v42
    v_lshlrev_b32 v42, 16, v42
    v_and_b32 v45, 0xffff0000, v44
    v_lshlrev_b32 v44, 16, v44
    v_and_b32 v47, 0xffff0000, v46
    v_lshlrev_b32 v46, 16, v46
    v_and_b32 v49, 0xffff0000, v48
    v_lshlrev_b32 v48, 16, v48
    v_and_b32 v51, 0xffff0000, v50
    v_lshlrev_b32 v50, 16, v50
    v_and_b32 v53, 0xffff0000, v52
    v_lshlrev_b32 v52, 16, v52
    v_and_b32 v55, 0xffff0000, v54
    v_lshlrev_b32 v54, 16, v54
    v_and_b32 v57, 0xffff0000, v56
    v_lshlrev_b32 v56, 16, v56
    v_and_b32 v59, 0xffff0000, v58
    v_lshlrev_b32 v58, 16, v58
    v_and_b32 v61, 0xffff0000, v60
    v_lshlrev_b32 v60, 16, v60
    v_and_b32 v63, 0xffff0000, v62
    v_lshlrev_b32 v62, 16, v62
    v_mul_f32 v96, v96, v98
    s_nop 1
    v_mul_f32_dpp v100, v96, v40 row_newbcast:0 row_mask:0xf bank_mask:0xf
    v_mul_f32_dpp v101, v96, v41 row_newbcast:0 row_mask:0xf bank_mask:0xf
    v_mul_f32_dpp v102, v96, v42 row_newbcast:0 row_mask:0xf bank_mask:0xf
    v_mul_f32_dpp v103, v96, v43 row_newbcast:0 row_mask:0xf bank_mask:0xf
    v_fmac_f32_dpp v100, v96, v44 row_newbcast:1 row_mask:0xf bank_mask:0xf
    v_fmac_f32_dpp v101, v96, v45 row_newbcast:1 row_mask:0xf bank_mask:0xf
    v_fmac_f32_dpp v102, v96, v46 row_newbcast:1 row_mask:0xf bank_mask:0xf
    v_fmac_f32_dpp v103, v96, v47 row_newbcast:1 row_mask:0xf bank_mask:0xf
    v_fmac_f32_dpp v100, v96, v48 row_newbcast:2 row_mask:0xf bank_mask:0xf
    v_fmac_f32_dpp v101, v96, v49 row_newbcast:2 row_mask:0xf bank_mask:0xf
    v_fmac_f32_dpp v102, v96, v50 row_newbcast:2 row_mask:0xf bank_mask:0xf
    v_fmac_f32_dpp v103, v96, v51 row_newbcast:2 row_mask:0xf bank_mask:0xf
    v_fmac_f32_dpp v100, v96, v52 row_newbcast:3 row_mask:0xf bank_mask:0xf
    v_fmac_f32_dpp v101, v96, v53 row_newbcast:3 row_mask:0xf bank_mask:0xf
    v_fmac_f32_dpp v102, v96, v54 row_newbcast:3 row_mask:0xf bank_mask:0xf
    v_fmac_f32_dpp v103, v96, v55 row_newbcast:3 row_mask:0xf bank_mask:0xf
    v_fmac_f32_dpp v100, v96, v56 row_newbcast:4 row_mask:0xf bank_mask:0xf
    v_fmac_f32_dpp v101, v96, v57 row_newbcast:4 row_mask:0xf bank_mask:0xf
    v_fmac_f32_dpp v102, v96, v58 row_newbcast:4 row_mask:0xf bank_mask:0xf
    v_fmac_f32_dpp v103, v96, v59 row_newbcast:4 row_mask:0xf bank_mask:0xf
    v_fmac_f32_dpp v100, v96, v60 row_newbcast:5 row_mask:0xf bank_mask:0xf
    v_fmac_f32_dpp v101, v96, v61 row_newbcast:5 row_mask:0xf bank_mask:0xf
    v_fmac_f32_dpp v102, v96, v62 row_newbcast:5 row_mask:0xf bank_mask:0xf
    v_fmac_f32_dpp v103, v96, v63 row_newbcast:5 row_mask:0xf bank_mask:0xf
    v_mov_b32 v104, v100
    v_mov_b32 v105, v101
    v_mov_b32 v106, v102
    v_mov_b32 v107, v103
    v_permlane32_swap_b32 v100, v104
    v_permlane32_swap_b32 v101, v105
    v_permlane32_swap_b32 v102, v106
    v_permlane32_swap_b32 v103, v107
    v_add_f32 v100, v100, v104
    v_add_f32 v101, v101, v105
    v_add_f32 v102, v102, v106
    v_add_f32 v103, v103, v107
    v_cvt_pk_bf16_f32 v100, v100, v100
    v_cvt_pk_bf16_f32 v101, v101, v101
    v_cvt_pk_bf16_f32 v102, v102, v102
    v_cvt_pk_bf16_f32 v103, v103, v103
    s_lshl_b32 s6, s4, 9
    s_add_u32 s6, s6, 140288
    v_add_u32 v7, s6, v9
    ds_write_b128 v7, v[100:103]
    s_branch L_t_k_15
L_t_a_13:
    s_lshl_b32 s91, s84, 1
    s_add_u32 s91, s91, s92
    s_lshl_b32 s91, s91, 11
    s_add_u32 s91, s91, 0x50000
    s_movk_i32 s88, 0x2000
L_x4a_retry_18:
    buffer_load_dwordx4 v[40:43], v6, s[52:55], s91 offen sc1
    buffer_load_dwordx4 v[44:47], v6, s[52:55], s91 offen offset:1024 sc1
    s_waitcnt vmcnt(0)
    v_xor_b32 v98, s5, v41
    v_bitop3_b32 v98, v98, v43, s5 bitop3:0xf6
    v_bitop3_b32 v98, v98, v45, s5 bitop3:0xf6
    v_bitop3_b32 v98, v98, v47, s5 bitop3:0xf6
    v_cmp_ne_u32 vcc, 0, v98
    s_cbranch_vccz L_x4a_ok_19
    s_sub_u32 s88, s88, 1
    s_cbranch_scc0 L_x4a_retry_18
L_x4a_ok_19:
    v_add_f32 v100, v40, v44
    v_add_f32 v101, v42, v46
L_t_j_14:
    v_cvt_pk_bf16_f32 v100, v100, v100
    v_cvt_pk_bf16_f32 v101, v101, v101
    s_lshl_b32 s6, s4, 9
    s_add_u32 s6, s6, 140288
    v_lshlrev_b32 v7, 3, v1
    v_add_u32 v7, s6, v7
    ds_write_b64 v7, v[100:101]
L_t_k_15:
    v_lshrrev_b32 v8, 3, v1
    v_lshlrev_b32 v8, 2, v8
    v_add_u32 v8, s6, v8
    ds_read2_b32 v[40:41], v8 offset0:0 offset1:8
    ds_read2_b32 v[42:43], v8 offset0:16 offset1:24
    ds_read2_b32 v[44:45], v8 offset0:32 offset1:40
    ds_read2_b32 v[46:47], v8 offset0:48 offset1:56
    ds_read2_b32 v[48:49], v8 offset0:64 offset1:72
    ds_read2_b32 v[50:51], v8 offset0:80 offset1:88
    ds_read2_b32 v[52:53], v8 offset0:96 offset1:104
    ds_read2_b32 v[54:55], v8 offset0:112 offset1:120
    s_waitcnt lgkmcnt(7)
    v_and_b32 v122, v2, v40
    v_and_b32 v123, v3, v40
    v_and_b32 v124, v4, v40
    v_and_b32 v125, v5, v40
    s_nop 1
    v_mfma_f32_16x16x32_bf16 v[10:13], v[140:143], v[122:125], 0
    v_and_b32 v126, v2, v41
    v_and_b32 v127, v3, v41
    v_and_b32 v128, v4, v41
    v_and_b32 v129, v5, v41
    s_nop 1
    v_mfma_f32_16x16x32_bf16 v[10:13], v[144:147], v[126:129], v[10:13]
    s_waitcnt lgkmcnt(6)
    v_and_b32 v122, v2, v42
    v_and_b32 v123, v3, v42
    v_and_b32 v124, v4, v42
    v_and_b32 v125, v5, v42
    s_nop 1
    v_mfma_f32_16x16x32_bf16 v[10:13], v[148:151], v[122:125], v[10:13]
    v_and_b32 v126, v2, v43
    v_and_b32 v127, v3, v43
    v_and_b32 v128, v4, v43
    v_and_b32 v129, v5, v43
    s_nop 1
    v_mfma_f32_16x16x32_bf16 v[10:13], v[152:155], v[126:129], v[10:13]
    s_waitcnt lgkmcnt(5)
    v_and_b32 v122, v2, v44
    v_and_b32 v123, v3, v44
    v_and_b32 v124, v4, v44
    v_and_b32 v125, v5, v44
    s_nop 1
    v_mfma_f32_16x16x32_bf16 v[10:13], v[156:159], v[122:125], v[10:13]
    v_and_b32 v126, v2, v45
    v_and_b32 v127, v3, v45
    v_and_b32 v128, v4, v45
    v_and_b32 v129, v5, v45
    s_nop 1
    v_mfma_f32_16x16x32_bf16 v[10:13], v[160:163], v[126:129], v[10:13]
    s_waitcnt lgkmcnt(4)
    v_and_b32 v122, v2, v46
    v_and_b32 v123, v3, v46
    v_and_b32 v124, v4, v46
    v_and_b32 v125, v5, v46
    s_nop 1
    v_mfma_f32_16x16x32_bf16 v[10:13], v[164:167], v[122:125], v[10:13]
    v_and_b32 v126, v2, v47
    v_and_b32 v127, v3, v47
    v_and_b32 v128, v4, v47
    v_and_b32 v129, v5, v47
    s_nop 1
    v_mfma_f32_16x16x32_bf16 v[10:13], v[168:171], v[126:129], v[10:13]
    s_waitcnt lgkmcnt(3)
    v_and_b32 v122, v2, v48
    v_and_b32 v123, v3, v48
    v_and_b32 v124, v4, v48
    v_and_b32 v125, v5, v48
    s_nop 1
    v_mfma_f32_16x16x32_bf16 v[10:13], v[172:175], v[122:125], v[10:13]
    v_and_b32 v126, v2, v49
    v_and_b32 v127, v3, v49
    v_and_b32 v128, v4, v49
    v_and_b32 v129, v5, v49
    s_nop 1
    v_mfma_f32_16x16x32_bf16 v[10:13], v[176:179], v[126:129], v[10:13]
    s_waitcnt lgkmcnt(2)
    v_and_b32 v122, v2, v50
    v_and_b32 v123, v3, v50
    v_and_b32 v124, v4, v50
    v_and_b32 v125, v5, v50
    s_nop 1
    v_mfma_f32_16x16x32_bf16 v[10:13], v[180:183], v[122:125], v[10:13]
    v_and_b32 v126, v2, v51
    v_and_b32 v127, v3, v51
    v_and_b32 v128, v4, v51
    v_and_b32 v129, v5, v51
    s_nop 1
    v_mfma_f32_16x16x32_bf16 v[10:13], v[184:187], v[126:129], v[10:13]
    s_waitcnt lgkmcnt(1)
    v_and_b32 v122, v2, v52
    v_and_b32 v123, v3, v52
    v_and_b32 v124, v4, v52
    v_and_b32 v125, v5, v52
    s_nop 1
    v_mfma_f32_16x16x32_bf16 v[10:13], v[188:191], v[122:125], v[10:13]
    v_and_b32 v126, v2, v53
    v_and_b32 v127, v3, v53
    v_and_b32 v128, v4, v53
    v_and_b32 v129, v5, v53
    s_nop 1
    v_mfma_f32_16x16x32_bf16 v[10:13], v[192:195], v[126:129], v[10:13]
    s_waitcnt lgkmcnt(0)
    v_and_b32 v122, v2, v54
    v_and_b32 v123, v3, v54
    v_and_b32 v124, v4, v54
    v_and_b32 v125, v5, v54
    s_nop 1
    v_mfma_f32_16x16x32_bf16 v[10:13], v[196:199], v[122:125], v[10:13]
    v_and_b32 v126, v2, v55
    v_and_b32 v127, v3, v55
    v_and_b32 v128, v4, v55
    v_and_b32 v129, v5, v55
    s_nop 1
    v_mfma_f32_16x16x32_bf16 v[10:13], v[200:203], v[126:129], v[10:13]
    s_nop 7
    v_mul_f32 v10, v10, v220
    v_mul_f32 v11, v11, v220
    v_mul_f32 v12, v12, v220
    v_mul_f32 v13, v13, v220
    v_lshrrev_b32 v7, 4, v1
    v_and_b32 v8, 1, v7
    v_lshlrev_b32 v8, 10, v8
    v_lshrrev_b32 v7, 1, v7
    v_lshlrev_b32 v7, 2, v7
    v_add_u32 v7, v7, v8
    v_and_b32 v8, 7, v1
    v_lshlrev_b32 v8, 5, v8
    s_lshl_b32 s6, s4, 3
    s_add_u32 s6, s6, 143360
    v_add3_u32 v7, v7, v8, s6
    s_mov_b32 s96, 0xff00ff
    s_mov_b32 s97, 0xff00ff00
    s_mov_b64 exec, s[96:97]
    ds_write_b32 v7, v10 offset:0
    ds_write_b32 v7, v11 offset:256
    ds_write_b32 v7, v12 offset:512
    ds_write_b32 v7, v13 offset:768
    s_mov_b64 exec, -1
    s_waitcnt lgkmcnt(0)
    s_barrier
    s_cmp_lg_u32 s4, 0
    s_cbranch_scc1 L_tail_done
    v_lshlrev_b32 v7, 5, v1
    v_add_u32 v7, 143360, v7
    ds_read_b128 v[40:43], v7
    ds_read_b128 v[44:47], v7 offset:16
    s_lshl_b32 s6, s85, 4
    s_add_u32 s6, s6, s84
    s_lshl_b32 s6, s6, 9
    s_add_u32 s6, s6, 0xe0000
    v_lshlrev_b32 v8, 3, v1
    s_waitcnt lgkmcnt(0)
    v_add_f32 v40, v40, v41
    v_add_f32 v42, v42, v43
    v_add_f32 v44, v44, v45
    v_add_f32 v46, v46, v47
    v_add_f32 v40, v40, v42
    v_add_f32 v44, v44, v46
    v_add_f32 v40, v40, v44
    v_mov_b32 v41, s5
    buffer_store_dwordx2 v[40:41], v8, s[52:55], s6 offen sc0 sc1
L_tail_done:
    s_endpgm
L_a_main:
    s_mov_b32 s91, s99
    v_xor_b32 v222, 0, v6
    v_xor_b32 v223, 32, v6
    v_xor_b32 v224, 64, v6
    v_xor_b32 v225, 96, v6
    v_xor_b32 v226, 128, v6
    v_xor_b32 v227, 160, v6
    v_xor_b32 v228, 192, v6
    v_xor_b32 v229, 224, v6
    s_lshl_b32 s98, s4, 13
    s_mov_b32 s99, s98
    s_mov_b32 s92, 0x8000
    s_mov_b32 m0, s98
    s_nop 0
    buffer_load_dwordx4 v222, s[60:63], s99 offen nt lds
    buffer_load_dwordx4 v223, s[60:63], s99 offen offset:1024 nt lds
    buffer_load_dwordx4 v224, s[60:63], s99 offen offset:2048 nt lds
    buffer_load_dwordx4 v225, s[60:63], s99 offen offset:3072 nt lds
    s_add_u32 s6, s98, 4096
    s_add_u32 s7, s99, 4096
    s_mov_b32 m0, s6
    s_nop 0
    buffer_load_dwordx4 v226, s[60:63], s7 offen nt lds
    buffer_load_dwordx4 v227, s[60:63], s7 offen offset:1024 nt lds
    buffer_load_dwordx4 v228, s[60:63], s7 offen offset:2048 nt lds
    buffer_load_dwordx4 v229, s[60:63], s7 offen offset:3072 nt lds
    v_lshrrev_b32 v7, 4, v1
    v_lshlrev_b32 v7, 13, v7
    v_and_b32 v8, 15, v1
    v_lshlrev_b32 v250, 4, v8
    v_add_u32 v250, v7, v250
    s_and_b32 s7, s2, 1
    s_lshl_b32 s7, s7, 2
    s_add_u32 s86, s7, s4
    s_lshl_b32 s86, s86, 19
    s_lshr_b32 s7, s2, 1
    s_lshl_b32 s7, s7, 8
    s_add_u32 s86, s86, s7
    buffer_load_dwordx4 a[128:131], v250, s[64:67], s86 offen nt
    s_add_u32 s86, s86, 0x8000
    buffer_load_dwordx4 a[132:135], v250, s[64:67], s86 offen nt
    s_add_u32 s86, s86, 0x8000
    buffer_load_dwordx4 a[136:139], v250, s[64:67], s86 offen nt
    s_add_u32 s86, s86, 0x8000
    buffer_load_dwordx4 a[140:143], v250, s[64:67], s86 offen nt
    s_add_u32 s86, s86, 0x8000
    buffer_load_dwordx4 a[144:147], v250, s[64:67], s86 offen nt
    s_add_u32 s86, s86, 0x8000
    buffer_load_dwordx4 a[148:151], v250, s[64:67], s86 offen nt
    s_add_u32 s86, s86, 0x8000
    buffer_load_dwordx4 a[152:155], v250, s[64:67], s86 offen nt
    s_add_u32 s86, s86, 0x8000
    buffer_load_dwordx4 a[156:159], v250, s[64:67], s86 offen nt
    s_add_u32 s86, s86, 0x8000
    buffer_load_dwordx4 a[160:163], v250, s[64:67], s86 offen nt
    s_add_u32 s86, s86, 0x8000
    buffer_load_dwordx4 a[164:167], v250, s[64:67], s86 offen nt
    s_add_u32 s86, s86, 0x8000
    buffer_load_dwordx4 a[168:171], v250, s[64:67], s86 offen nt
    s_add_u32 s86, s86, 0x8000
    buffer_load_dwordx4 a[172:175], v250, s[64:67], s86 offen nt
    s_add_u32 s86, s86, 0x8000
    buffer_load_dwordx4 a[176:179], v250, s[64:67], s86 offen nt
    s_add_u32 s86, s86, 0x8000
    buffer_load_dwordx4 a[180:183], v250, s[64:67], s86 offen nt
    s_add_u32 s86, s86, 0x8000
    buffer_load_dwordx4 a[184:187], v250, s[64:67], s86 offen nt
    s_add_u32 s86, s86, 0x8000
    buffer_load_dwordx4 a[188:191], v250, s[64:67], s86 offen nt
    s_movk_i32 s88, 0x2000
L_x1a_retry_20:
    buffer_load_dwordx4 v[88:91], v6, s[52:55], s91 offen sc1
    s_waitcnt vmcnt(0)
    v_xor_b32 v242, s5, v89
    v_bitop3_b32 v242, v242, v91, s5 bitop3:0xf6
    v_cmp_ne_u32 vcc, 0, v242
    s_cbranch_vccz L_x1a_ok_21
    s_sub_u32 s88, s88, 1
    s_cbranch_scc0 L_x1a_retry_20
L_x1a_ok_21:
    s_lshl_b32 s6, s4, 2
    s_add_u32 s6, s6, 135168
    v_add_u32 v7, s6, v6
    v_mov_b32 v89, v88
    v_mov_b32 v91, v90
    s_nop 0
    v_permlane16_swap_b32 v88, v89
    v_permlane16_swap_b32 v90, v91
    v_add_f32 v88, v88, v89
    v_add_f32 v90, v90, v91
    v_cvt_pk_bf16_f32 v88, v88, v90
    ds_write_b32 v7, v88 offset:0
    v_add_u32 v7, 135168, v6
    s_waitcnt lgkmcnt(0)
    s_barrier
    s_bitcmp1_b32 s21, 3
    s_cselect_b64 s[96:97], -1, 0
    ds_read_b128 v[242:245], v7 offset:0
    s_waitcnt lgkmcnt(0)
    v_mov_b32 v246, v242
    v_mov_b32 v247, v243
    v_mov_b32 v248, v244
    v_mov_b32 v249, v245
    v_permlane32_swap_b32 v242, v246
    v_permlane32_swap_b32 v243, v247
    v_permlane32_swap_b32 v244, v248
    v_permlane32_swap_b32 v245, v249
    v_cndmask_b32 v16, v242, v246, s[96:97]
    v_cndmask_b32 v17, v243, v247, s[96:97]
    v_cndmask_b32 v18, v244, v248, s[96:97]
    v_cndmask_b32 v19, v245, v249, s[96:97]
    v_dot2_f32_bf16 v20, v56, v16, 0
    v_dot2_f32_bf16 v21, v60, v16, 0
    v_dot2_f32_bf16 v22, v64, v16, 0
    v_dot2_f32_bf16 v23, v68, v16, 0
    v_dot2_f32_bf16 v20, v57, v17, v20
    v_dot2_f32_bf16 v21, v61, v17, v21
    v_dot2_f32_bf16 v22, v65, v17, v22
    v_dot2_f32_bf16 v23, v69, v17, v23
    v_dot2_f32_bf16 v20, v58, v18, v20
    v_dot2_f32_bf16 v21, v62, v18, v21
    v_dot2_f32_bf16 v22, v66, v18, v22
    v_dot2_f32_bf16 v23, v70, v18, v23
    v_dot2_f32_bf16 v20, v59, v19, v20
    v_dot2_f32_bf16 v21, v63, v19, v21
    v_dot2_f32_bf16 v22, v67, v19, v22
    v_dot2_f32_bf16 v23, v71, v19, v23
    v_add_f32_dpp v20, v20, v20 row_ror:8 row_mask:0xf bank_mask:0xf
    v_add_f32_dpp v21, v21, v21 row_ror:8 row_mask:0xf bank_mask:0xf
    v_add_f32_dpp v22, v22, v22 row_ror:8 row_mask:0xf bank_mask:0xf
    v_add_f32_dpp v23, v23, v23 row_ror:8 row_mask:0xf bank_mask:0xf
    v_add_f32_dpp v20, v20, v20 quad_perm:[1,0,3,2] row_mask:0xf bank_mask:0xf
    v_add_f32_dpp v21, v21, v21 quad_perm:[1,0,3,2] row_mask:0xf bank_mask:0xf
    v_add_f32_dpp v22, v22, v22 quad_perm:[1,0,3,2] row_mask:0xf bank_mask:0xf
    v_add_f32_dpp v23, v23, v23 quad_perm:[1,0,3,2] row_mask:0xf bank_mask:0xf
    v_add_f32_dpp v20, v20, v20 quad_perm:[2,3,0,1] row_mask:0xf bank_mask:0xf
    v_add_f32_dpp v21, v21, v21 quad_perm:[2,3,0,1] row_mask:0xf bank_mask:0xf
    v_add_f32_dpp v22, v22, v22 quad_perm:[2,3,0,1] row_mask:0xf bank_mask:0xf
    v_add_f32_dpp v23, v23, v23 quad_perm:[2,3,0,1] row_mask:0xf bank_mask:0xf
    v_add_f32_dpp v20, v20, v20 row_half_mirror row_mask:0xf bank_mask:0xf
    v_add_f32_dpp v21, v21, v21 row_half_mirror row_mask:0xf bank_mask:0xf
    v_add_f32_dpp v22, v22, v22 row_half_mirror row_mask:0xf bank_mask:0xf
    v_add_f32_dpp v23, v23, v23 row_half_mirror row_mask:0xf bank_mask:0xf
    v_cvt_pk_bf16_f32 v24, v20, v21
    v_cvt_pk_bf16_f32 v26, v22, v23
    v_mov_b32 v25, s5
    v_mov_b32 v27, s5
    s_lshl_b32 s6, s21, 8
    s_lshl_b32 s7, s4, 6
    s_add_u32 s6, s6, s7
    s_add_u32 s6, s6, 0x30000
    s_mov_b32 s96, 0x10001
    s_mov_b32 s97, 0x10001
    s_mov_b64 exec, s[96:97]
    buffer_store_dwordx4 v[24:27], v1, s[52:55], s6 offen sc0 sc1
    s_mov_b64 exec, -1
    s_add_u32 s99, s99, 0x8000
    s_xor_b32 s98, s98, s92
    s_xor_b32 s92, s92, 0x18000
    s_mov_b32 m0, s98
    s_nop 0
    buffer_load_dwordx4 v222, s[60:63], s99 offen nt lds
    buffer_load_dwordx4 v223, s[60:63], s99 offen offset:1024 nt lds
    buffer_load_dwordx4 v224, s[60:63], s99 offen offset:2048 nt lds
    buffer_load_dwordx4 v225, s[60:63], s99 offen offset:3072 nt lds
    s_add_u32 s6, s98, 4096
    s_add_u32 s7, s99, 4096
    s_mov_b32 m0, s6
    s_nop 0
    buffer_load_dwordx4 v226, s[60:63], s7 offen nt lds
    buffer_load_dwordx4 v227, s[60:63], s7 offen offset:1024 nt lds
    buffer_load_dwordx4 v228, s[60:63], s7 offen offset:2048 nt lds
    buffer_load_dwordx4 v229, s[60:63], s7 offen offset:3072 nt lds
    s_lshl_b32 s91, s4, 14
    s_add_u32 s91, s91, 0x30000
    s_movk_i32 s88, 0x2000
L_x2_retry_22:
    s_mov_b32 s87, s91
    buffer_load_dwordx4 v[40:43], v6, s[52:55], s87 offen sc1
    buffer_load_dwordx4 v[44:47], v6, s[52:55], s87 offen offset:1024 sc1
    buffer_load_dwordx4 v[48:51], v6, s[52:55], s87 offen offset:2048 sc1
    buffer_load_dwordx4 v[52:55], v6, s[52:55], s87 offen offset:3072 sc1
    s_add_u32 s87, s87, 4096
    buffer_load_dwordx4 v[56:59], v6, s[52:55], s87 offen sc1
    buffer_load_dwordx4 v[60:63], v6, s[52:55], s87 offen offset:1024 sc1
    buffer_load_dwordx4 v[64:67], v6, s[52:55], s87 offen offset:2048 sc1
    buffer_load_dwordx4 v[68:71], v6, s[52:55], s87 offen offset:3072 sc1
    s_add_u32 s87, s87, 4096
    buffer_load_dwordx4 v[72:75], v6, s[52:55], s87 offen sc1
    buffer_load_dwordx4 v[76:79], v6, s[52:55], s87 offen offset:1024 sc1
    buffer_load_dwordx4 v[80:83], v6, s[52:55], s87 offen offset:2048 sc1
    buffer_load_dwordx4 v[84:87], v6, s[52:55], s87 offen offset:3072 sc1
    s_add_u32 s87, s87, 4096
    buffer_load_dwordx4 v[88:91], v6, s[52:55], s87 offen sc1
    buffer_load_dwordx4 v[92:95], v6, s[52:55], s87 offen offset:1024 sc1
    buffer_load_dwordx4 v[96:99], v6, s[52:55], s87 offen offset:2048 sc1
    buffer_load_dwordx4 v[100:103], v6, s[52:55], s87 offen offset:3072 sc1
    s_waitcnt vmcnt(0)
    v_xor_b32 v104, s5, v41
    v_bitop3_b32 v104, v104, v43, s5 bitop3:0xf6
    v_bitop3_b32 v104, v104, v45, s5 bitop3:0xf6
    v_bitop3_b32 v104, v104, v47, s5 bitop3:0xf6
    v_bitop3_b32 v104, v104, v49, s5 bitop3:0xf6
    v_bitop3_b32 v104, v104, v51, s5 bitop3:0xf6
    v_bitop3_b32 v104, v104, v53, s5 bitop3:0xf6
    v_bitop3_b32 v104, v104, v55, s5 bitop3:0xf6
    v_bitop3_b32 v104, v104, v57, s5 bitop3:0xf6
    v_bitop3_b32 v104, v104, v59, s5 bitop3:0xf6
    v_bitop3_b32 v104, v104, v61, s5 bitop3:0xf6
    v_bitop3_b32 v104, v104, v63, s5 bitop3:0xf6
    v_bitop3_b32 v104, v104, v65, s5 bitop3:0xf6
    v_bitop3_b32 v104, v104, v67, s5 bitop3:0xf6
    v_bitop3_b32 v104, v104, v69, s5 bitop3:0xf6
    v_bitop3_b32 v104, v104, v71, s5 bitop3:0xf6
    v_bitop3_b32 v104, v104, v73, s5 bitop3:0xf6
    v_bitop3_b32 v104, v104, v75, s5 bitop3:0xf6
    v_bitop3_b32 v104, v104, v77, s5 bitop3:0xf6
    v_bitop3_b32 v104, v104, v79, s5 bitop3:0xf6
    v_bitop3_b32 v104, v104, v81, s5 bitop3:0xf6
    v_bitop3_b32 v104, v104, v83, s5 bitop3:0xf6
    v_bitop3_b32 v104, v104, v85, s5 bitop3:0xf6
    v_bitop3_b32 v104, v104, v87, s5 bitop3:0xf6
    v_bitop3_b32 v104, v104, v89, s5 bitop3:0xf6
    v_bitop3_b32 v104, v104, v91, s5 bitop3:0xf6
    v_bitop3_b32 v104, v104, v93, s5 bitop3:0xf6
    v_bitop3_b32 v104, v104, v95, s5 bitop3:0xf6
    v_bitop3_b32 v104, v104, v97, s5 bitop3:0xf6
    v_bitop3_b32 v104, v104, v99, s5 bitop3:0xf6
    v_bitop3_b32 v104, v104, v101, s5 bitop3:0xf6
    v_bitop3_b32 v104, v104, v103, s5 bitop3:0xf6
    v_cmp_ne_u32 vcc, 0, v104
    s_cbranch_vccz L_x2_ok_23
    s_sub_u32 s88, s88, 1
    s_cbranch_scc0 L_x2_retry_22
L_x2_ok_23:
    s_add_u32 s99, s99, 0x8000
    s_xor_b32 s98, s98, s92
    s_xor_b32 s92, s92, 0x18000
    s_mov_b32 m0, s98
    s_nop 0
    buffer_load_dwordx4 v222, s[60:63], s99 offen nt lds
    buffer_load_dwordx4 v223, s[60:63], s99 offen offset:1024 nt lds
    buffer_load_dwordx4 v224, s[60:63], s99 offen offset:2048 nt lds
    buffer_load_dwordx4 v225, s[60:63], s99 offen offset:3072 nt lds
    s_add_u32 s6, s98, 4096
    s_add_u32 s7, s99, 4096
    s_mov_b32 m0, s6
    s_nop 0
    buffer_load_dwordx4 v226, s[60:63], s7 offen nt lds
    v_lshrrev_b32 v7, 1, v1
    v_lshlrev_b32 v7, 4, v7
    v_and_b32 v8, 1, v1
    v_lshlrev_b32 v8, 3, v8
    s_lshl_b32 s6, s4, 13
    s_add_u32 s6, s6, 131072
    v_add_u32 v7, v7, v8
    v_xor_b32 v104, 0, v7
    v_add_u32 v104, s6, v104
    v_xor_b32 v105, 32, v7
    v_add_u32 v105, s6, v105
    v_xor_b32 v106, 64, v7
    v_add_u32 v106, s6, v106
    v_xor_b32 v107, 96, v7
    v_add_u32 v107, s6, v107
    v_xor_b32 v108, 128, v7
    v_add_u32 v108, s6, v108
    v_xor_b32 v109, 160, v7
    v_add_u32 v109, s6, v109
    v_xor_b32 v110, 192, v7
    v_add_u32 v110, s6, v110
    v_xor_b32 v111, 224, v7
    v_add_u32 v111, s6, v111
    v_mov_b32 v41, v42
    v_mov_b32 v45, v46
    v_mov_b32 v49, v50
    v_mov_b32 v53, v54
    v_mov_b32 v57, v58
    v_mov_b32 v61, v62
    v_mov_b32 v65, v66
    v_mov_b32 v69, v70
    v_mov_b32 v73, v74
    v_mov_b32 v77, v78
    v_mov_b32 v81, v82
    v_mov_b32 v85, v86
    v_mov_b32 v89, v90
    v_mov_b32 v93, v94
    v_mov_b32 v97, v98
    v_mov_b32 v101, v102
    ds_write_b64 v104, v[40:41] offset:0
    ds_write_b64 v104, v[44:45] offset:512
    ds_write_b64 v105, v[48:49] offset:1024
    ds_write_b64 v105, v[52:53] offset:1536
    ds_write_b64 v106, v[56:57] offset:2048
    ds_write_b64 v106, v[60:61] offset:2560
    ds_write_b64 v107, v[64:65] offset:3072
    ds_write_b64 v107, v[68:69] offset:3584
    ds_write_b64 v108, v[72:73] offset:4096
    ds_write_b64 v108, v[76:77] offset:4608
    ds_write_b64 v109, v[80:81] offset:5120
    ds_write_b64 v109, v[84:85] offset:5632
    ds_write_b64 v110, v[88:89] offset:6144
    ds_write_b64 v110, v[92:93] offset:6656
    ds_write_b64 v111, v[96:97] offset:7168
    ds_write_b64 v111, v[100:101] offset:7680
    v_and_b32 v7, 15, v1
    v_lshlrev_b32 v8, 10, v7
    v_and_b32 v7, 7, v7
    v_lshlrev_b32 v7, 5, v7
    v_lshrrev_b32 v9, 4, v1
    v_lshlrev_b32 v9, 4, v9
    v_add_u32 v210, 0, v9
    v_xor_b32 v210, v210, v7
    v_add_u32 v210, v210, v8
    v_add_u32 v211, 64, v9
    v_xor_b32 v211, v211, v7
    v_add_u32 v211, v211, v8
    v_add_u32 v212, 128, v9
    v_xor_b32 v212, v212, v7
    v_add_u32 v212, v212, v8
    v_add_u32 v213, 192, v9
    v_xor_b32 v213, v213, v7
    v_add_u32 v213, v213, v8
    s_waitcnt lgkmcnt(0)
    s_barrier
    s_lshr_b32 s6, s4, 1
    s_lshl_b32 s6, s6, 14
    s_add_u32 s6, s6, 131072
    v_add_u32 v112, s6, v210
    v_add_u32 v113, s6, v211
    v_add_u32 v114, s6, v212
    v_add_u32 v115, s6, v213
    ds_read_b128 a[0:3], v112 offset:0
    ds_read_b128 a[4:7], v113 offset:0
    ds_read_b128 a[8:11], v114 offset:0
    ds_read_b128 a[12:15], v115 offset:0
    ds_read_b128 a[16:19], v112 offset:256
    ds_read_b128 a[20:23], v113 offset:256
    ds_read_b128 a[24:27], v114 offset:256
    ds_read_b128 a[28:31], v115 offset:256
    ds_read_b128 a[32:35], v112 offset:512
    ds_read_b128 a[36:39], v113 offset:512
    ds_read_b128 a[40:43], v114 offset:512
    ds_read_b128 a[44:47], v115 offset:512
    ds_read_b128 a[48:51], v112 offset:768
    ds_read_b128 a[52:55], v113 offset:768
    ds_read_b128 a[56:59], v114 offset:768
    ds_read_b128 a[60:63], v115 offset:768
    s_and_b32 s6, s4, 1
    s_lshl_b32 s6, s6, 14
    v_add_u32 v210, s6, v210
    v_add_u32 v211, s6, v211
    v_add_u32 v212, s6, v212
    v_add_u32 v213, s6, v213
    v_lshrrev_b32 v7, 4, v1
    v_lshlrev_b32 v7, 2, v7
    v_bfe_u32 v8, v1, 2, 2
    v_add_u32 v7, v7, v8
    v_and_b32 v8, 7, v7
    v_lshlrev_b32 v8, 5, v8
    v_lshlrev_b32 v7, 10, v7
    v_and_b32 v9, 3, v1
    v_lshlrev_b32 v9, 3, v9
    s_lshl_b32 s6, s4, 8
    v_add3_u32 v7, v7, v9, s6
    v_xor_b32 v214, 0, v8
    v_add_u32 v214, v214, v7
    v_xor_b32 v215, 32, v8
    v_add_u32 v215, v215, v7
    v_xor_b32 v216, 64, v8
    v_add_u32 v216, v216, v7
    v_xor_b32 v217, 96, v8
    v_add_u32 v217, v217, v7
    v_xor_b32 v218, 128, v8
    v_add_u32 v218, v218, v7
    v_xor_b32 v219, 160, v8
    v_add_u32 v219, v219, v7
    v_xor_b32 v220, 192, v8
    v_add_u32 v220, v220, v7
    v_xor_b32 v221, 224, v8
    v_add_u32 v221, v221, v7
    v_and_b32 v7, 15, v1
    v_lshlrev_b32 v7, 4, v7
    v_add_u32 v231, 131072, v7
    s_lshr_b32 s6, s4, 1
    s_and_b32 s7, s4, 1
    s_lshl_b32 s87, s6, 3
    s_lshl_b32 s91, s7, 2
    s_add_u32 s87, s87, s91
    v_add_u32 v230, s87, v231
    v_add_u32 v233, 132096, v6
    s_lshl_b32 s87, s6, 10
    s_lshl_b32 s91, s7, 3
    s_add_u32 s87, s87, s91
    v_add_u32 v232, s87, v233
    s_cmp_ge_u32 s4, 2
    s_cselect_b64 s[94:95], -1, 0
    v_mov_b32 v40, 0
    v_mov_b32 v41, 0
    v_mov_b32 v42, 0
    v_mov_b32 v43, 0
    v_mov_b32 v44, 0
    v_mov_b32 v45, 0
    v_mov_b32 v46, 0
    v_mov_b32 v47, 0
    v_mov_b32 v48, 0
    v_mov_b32 v49, 0
    v_mov_b32 v50, 0
    v_mov_b32 v51, 0
    v_mov_b32 v52, 0
    v_mov_b32 v53, 0
    v_mov_b32 v54, 0
    v_mov_b32 v55, 0
    v_mov_b32 v56, 0
    v_mov_b32 v57, 0
    v_mov_b32 v58, 0
    v_mov_b32 v59, 0
    v_mov_b32 v60, 0
    v_mov_b32 v61, 0
    v_mov_b32 v62, 0
    v_mov_b32 v63, 0
    v_mov_b32 v64, 0
    v_mov_b32 v65, 0
    v_mov_b32 v66, 0
    v_mov_b32 v67, 0
    v_mov_b32 v68, 0
    v_mov_b32 v69, 0
    v_mov_b32 v70, 0
    v_mov_b32 v71, 0
    v_mov_b32 v72, 0
    v_mov_b32 v73, 0
    v_mov_b32 v74, 0
    v_mov_b32 v75, 0
    v_mov_b32 v76, 0
    v_mov_b32 v77, 0
    v_mov_b32 v78, 0
    v_mov_b32 v79, 0
    v_mov_b32 v80, 0
    v_mov_b32 v81, 0
    v_mov_b32 v82, 0
    v_mov_b32 v83, 0
    v_mov_b32 v84, 0
    v_mov_b32 v85, 0
    v_mov_b32 v86, 0
    v_mov_b32 v87, 0
    v_mov_b32 v88, 0
    v_mov_b32 v89, 0
    v_mov_b32 v90, 0
    v_mov_b32 v91, 0
    v_mov_b32 v92, 0
    v_mov_b32 v93, 0
    v_mov_b32 v94, 0
    v_mov_b32 v95, 0
    v_mov_b32 v96, 0
    v_mov_b32 v97, 0
    v_mov_b32 v98, 0
    v_mov_b32 v99, 0
    v_mov_b32 v100, 0
    v_mov_b32 v101, 0
    v_mov_b32 v102, 0
    v_mov_b32 v103, 0
    v_mov_b32 v176, 0xff800000
    v_mov_b32 v177, 0xff800000
    v_mov_b32 v178, 0
    s_waitcnt lgkmcnt(0)
    s_barrier
    s_mov_b32 s89, 0
    s_mov_b32 s87, 0x8000
L_a_loop_24:
    ds_read_b128 v[104:107], v210 offset:0
    ds_read_b128 v[108:111], v211 offset:0
    ds_read_b128 v[112:115], v212 offset:0
    ds_read_b128 v[116:119], v213 offset:0
    ds_read_b128 v[120:123], v210 offset:256
    ds_read_b128 v[124:127], v211 offset:256
    ds_read_b128 v[128:131], v212 offset:256
    ds_read_b128 v[132:135], v213 offset:256
    ds_read_b128 v[136:139], v210 offset:512
    ds_read_b128 v[140:143], v211 offset:512
    ds_read_b128 v[144:147], v212 offset:512
    ds_read_b128 v[148:151], v213 offset:512
    ds_read_b128 v[152:155], v210 offset:768
    ds_read_b128 v[156:159], v211 offset:768
    ds_read_b128 v[160:163], v212 offset:768
    ds_read_b128 v[164:167], v213 offset:768
    s_waitcnt lgkmcnt(15)
    v_mfma_f32_16x16x32_bf16 v[168:171], v[104:107], a[0:3], 0
    s_waitcnt lgkmcnt(14)
    v_mfma_f32_16x16x32_bf16 v[172:175], v[108:111], a[4:7], 0
    s_waitcnt lgkmcnt(13)
    v_mfma_f32_16x16x32_bf16 v[168:171], v[112:115], a[8:11], v[168:171]
    s_waitcnt lgkmcnt(12)
    v_mfma_f32_16x16x32_bf16 v[172:175], v[116:119], a[12:15], v[172:175]
    s_waitcnt lgkmcnt(11)
    v_mfma_f32_16x16x32_bf16 v[168:171], v[120:123], a[16:19], v[168:171]
    s_add_u32 s6, s98, 4096
    s_add_u32 s7, s99, 4096
    s_mov_b32 m0, s6
    s_nop 0
    buffer_load_dwordx4 v227, s[60:63], s7 offen offset:1024 nt lds
    s_waitcnt lgkmcnt(10)
    v_mfma_f32_16x16x32_bf16 v[172:175], v[124:127], a[20:23], v[172:175]
    s_waitcnt lgkmcnt(9)
    v_mfma_f32_16x16x32_bf16 v[168:171], v[128:131], a[24:27], v[168:171]
    s_waitcnt lgkmcnt(8)
    v_mfma_f32_16x16x32_bf16 v[172:175], v[132:135], a[28:31], v[172:175]
    s_waitcnt lgkmcnt(7)
    v_mfma_f32_16x16x32_bf16 v[168:171], v[136:139], a[32:35], v[168:171]
    s_add_u32 s6, s98, 4096
    s_add_u32 s7, s99, 4096
    s_mov_b32 m0, s6
    s_nop 0
    buffer_load_dwordx4 v228, s[60:63], s7 offen offset:2048 nt lds
    s_waitcnt lgkmcnt(6)
    v_mfma_f32_16x16x32_bf16 v[172:175], v[140:143], a[36:39], v[172:175]
    s_waitcnt lgkmcnt(5)
    v_mfma_f32_16x16x32_bf16 v[168:171], v[144:147], a[40:43], v[168:171]
    s_waitcnt lgkmcnt(4)
    v_mfma_f32_16x16x32_bf16 v[172:175], v[148:151], a[44:47], v[172:175]
    s_waitcnt lgkmcnt(3)
    v_mfma_f32_16x16x32_bf16 v[168:171], v[152:155], a[48:51], v[168:171]
    s_add_u32 s6, s98, 4096
    s_add_u32 s7, s99, 4096
    s_mov_b32 m0, s6
    s_nop 0
    buffer_load_dwordx4 v229, s[60:63], s7 offen offset:3072 nt lds
    s_waitcnt lgkmcnt(2)
    v_mfma_f32_16x16x32_bf16 v[172:175], v[156:159], a[52:55], v[172:175]
    s_waitcnt lgkmcnt(1)
    v_mfma_f32_16x16x32_bf16 v[168:171], v[160:163], a[56:59], v[168:171]
    s_waitcnt lgkmcnt(0)
    v_mfma_f32_16x16x32_bf16 v[172:175], v[164:167], a[60:63], v[172:175]
    s_nop 7
    v_add_f32 v168, v168, v172
    v_add_f32 v169, v169, v173
    v_add_f32 v170, v170, v174
    v_add_f32 v171, v171, v175
    v_max3_f32 v198, v168, v169, v170
    v_max_f32 v198, v198, v171
    v_mov_b32 v199, v198
    s_nop 1
    v_permlane16_swap_b32 v198, v199
    v_max_f32 v198, v198, v199
    v_mov_b32 v199, v198
    s_nop 1
    v_permlane32_swap_b32 v198, v199
    v_max_f32 v198, v198, v199
    ds_write_b32 v230, v198
    s_waitcnt lgkmcnt(0)
    s_barrier
    ds_read_b128 v[198:201], v231
    s_add_u32 s99, s99, 0x8000
    s_xor_b32 s98, s98, s92
    s_xor_b32 s92, s92, 0x18000
    s_cmp_ge_u32 s89, 5
    s_cselect_b32 s62, 0, 262144
    s_mov_b32 m0, s98
    s_nop 0
    buffer_load_dwordx4 v222, s[60:63], s99 offen nt lds
    buffer_load_dwordx4 v223, s[60:63], s99 offen offset:1024 nt lds
    s_waitcnt lgkmcnt(0)
    v_max3_f32 v198, v198, v199, v176
    v_max3_f32 v200, v200, v201, v177
    v_cndmask_b32 v199, v198, v200, s[94:95]
    v_sub_f32 v180, v176, v198
    v_sub_f32 v181, v177, v200
    v_sub_f32 v168, v168, v199
    v_sub_f32 v169, v169, v199
    v_sub_f32 v170, v170, v199
    v_sub_f32 v171, v171, v199
    v_exp_f32 v180, v180
    v_exp_f32 v181, v181
    v_exp_f32 v168, v168
    v_exp_f32 v169, v169
    v_exp_f32 v170, v170
    v_exp_f32 v171, v171
    v_mov_b32 v176, v198
    v_mov_b32 v177, v200
    v_cvt_pk_bf16_f32 v198, v168, v169
    v_cvt_pk_bf16_f32 v199, v170, v171
    ds_write_b64 v232, v[198:199]
    v_cndmask_b32 v200, v180, v181, s[94:95]
    v_add_f32 v168, v168, v169
    v_add_f32 v170, v170, v171
    v_add_f32 v168, v168, v170
    v_fma_f32 v178, v178, v200, v168
    v_pk_mul_f32 v[40:41], v[40:41], v[180:181] op_sel_hi:[1,0]
    v_pk_mul_f32 v[42:43], v[42:43], v[180:181] op_sel_hi:[1,0]
    v_pk_mul_f32 v[44:45], v[44:45], v[180:181] op_sel:[0,1] op_sel_hi:[1,1]
    v_pk_mul_f32 v[46:47], v[46:47], v[180:181] op_sel:[0,1] op_sel_hi:[1,1]
    s_cmp_eq_u32 s89, 0
    s_cbranch_scc1 L_a_nw_25
    s_waitcnt vmcnt(10)
L_a_nw_25:
    s_waitcnt lgkmcnt(0)
    s_barrier
    ds_read_b128 v[182:185], v233 offset:0
    ds_read_b128 v[186:189], v233 offset:1024
    ds_read_b64_tr_b16 v[104:105], v214 offset:0
    ds_read_b64_tr_b16 v[106:107], v214 offset:16384
    ds_read_b64_tr_b16 v[108:109], v215 offset:0
    ds_read_b64_tr_b16 v[110:111], v215 offset:16384
    ds_read_b64_tr_b16 v[112:113], v216 offset:0
    ds_read_b64_tr_b16 v[114:115], v216 offset:16384
    ds_read_b64_tr_b16 v[116:117], v217 offset:0
    ds_read_b64_tr_b16 v[118:119], v217 offset:16384
    ds_read_b64_tr_b16 v[120:121], v218 offset:0
    ds_read_b64_tr_b16 v[122:123], v218 offset:16384
    ds_read_b64_tr_b16 v[124:125], v219 offset:0
    ds_read_b64_tr_b16 v[126:127], v219 offset:16384
    v_pk_mul_f32 v[48:49], v[48:49], v[180:181] op_sel_hi:[1,0]
    v_pk_mul_f32 v[50:51], v[50:51], v[180:181] op_sel_hi:[1,0]
    v_pk_mul_f32 v[52:53], v[52:53], v[180:181] op_sel:[0,1] op_sel_hi:[1,1]
    v_pk_mul_f32 v[54:55], v[54:55], v[180:181] op_sel:[0,1] op_sel_hi:[1,1]
    s_waitcnt lgkmcnt(10)
    v_mfma_f32_16x16x32_bf16 v[40:43], v[104:107], v[182:185], v[40:43]
    v_mfma_f32_16x16x32_bf16 v[44:47], v[104:107], v[186:189], v[44:47]
    ds_read_b64_tr_b16 v[128:129], v220 offset:0
    ds_read_b64_tr_b16 v[130:131], v220 offset:16384
    v_pk_mul_f32 v[56:57], v[56:57], v[180:181] op_sel_hi:[1,0]
    v_pk_mul_f32 v[58:59], v[58:59], v[180:181] op_sel_hi:[1,0]
    v_pk_mul_f32 v[60:61], v[60:61], v[180:181] op_sel:[0,1] op_sel_hi:[1,1]
    v_pk_mul_f32 v[62:63], v[62:63], v[180:181] op_sel:[0,1] op_sel_hi:[1,1]
    s_waitcnt lgkmcnt(10)
    v_mfma_f32_16x16x32_bf16 v[48:51], v[108:111], v[182:185], v[48:51]
    v_mfma_f32_16x16x32_bf16 v[52:55], v[108:111], v[186:189], v[52:55]
    ds_read_b64_tr_b16 v[132:133], v221 offset:0
    ds_read_b64_tr_b16 v[134:135], v221 offset:16384
    s_mov_b32 m0, s98
    s_nop 0
    buffer_load_dwordx4 v224, s[60:63], s99 offen offset:2048 nt lds
    v_pk_mul_f32 v[64:65], v[64:65], v[180:181] op_sel_hi:[1,0]
    v_pk_mul_f32 v[66:67], v[66:67], v[180:181] op_sel_hi:[1,0]
    v_pk_mul_f32 v[68:69], v[68:69], v[180:181] op_sel:[0,1] op_sel_hi:[1,1]
    v_pk_mul_f32 v[70:71], v[70:71], v[180:181] op_sel:[0,1] op_sel_hi:[1,1]
    s_waitcnt lgkmcnt(10)
    v_mfma_f32_16x16x32_bf16 v[56:59], v[112:115], v[182:185], v[56:59]
    v_mfma_f32_16x16x32_bf16 v[60:63], v[112:115], v[186:189], v[60:63]
    v_pk_mul_f32 v[72:73], v[72:73], v[180:181] op_sel_hi:[1,0]
    v_pk_mul_f32 v[74:75], v[74:75], v[180:181] op_sel_hi:[1,0]
    v_pk_mul_f32 v[76:77], v[76:77], v[180:181] op_sel:[0,1] op_sel_hi:[1,1]
    v_pk_mul_f32 v[78:79], v[78:79], v[180:181] op_sel:[0,1] op_sel_hi:[1,1]
    s_waitcnt lgkmcnt(8)
    v_mfma_f32_16x16x32_bf16 v[64:67], v[116:119], v[182:185], v[64:67]
    v_mfma_f32_16x16x32_bf16 v[68:71], v[116:119], v[186:189], v[68:71]
    s_mov_b32 m0, s98
    s_nop 0
    buffer_load_dwordx4 v225, s[60:63], s99 offen offset:3072 nt lds
    v_pk_mul_f32 v[80:81], v[80:81], v[180:181] op_sel_hi:[1,0]
    v_pk_mul_f32 v[82:83], v[82:83], v[180:181] op_sel_hi:[1,0]
    v_pk_mul_f32 v[84:85], v[84:85], v[180:181] op_sel:[0,1] op_sel_hi:[1,1]
    v_pk_mul_f32 v[86:87], v[86:87], v[180:181] op_sel:[0,1] op_sel_hi:[1,1]
    s_waitcnt lgkmcnt(6)
    v_mfma_f32_16x16x32_bf16 v[72:75], v[120:123], v[182:185], v[72:75]
    v_mfma_f32_16x16x32_bf16 v[76:79], v[120:123], v[186:189], v[76:79]
    v_pk_mul_f32 v[88:89], v[88:89], v[180:181] op_sel_hi:[1,0]
    v_pk_mul_f32 v[90:91], v[90:91], v[180:181] op_sel_hi:[1,0]
    v_pk_mul_f32 v[92:93], v[92:93], v[180:181] op_sel:[0,1] op_sel_hi:[1,1]
    v_pk_mul_f32 v[94:95], v[94:95], v[180:181] op_sel:[0,1] op_sel_hi:[1,1]
    s_waitcnt lgkmcnt(4)
    v_mfma_f32_16x16x32_bf16 v[80:83], v[124:127], v[182:185], v[80:83]
    v_mfma_f32_16x16x32_bf16 v[84:87], v[124:127], v[186:189], v[84:87]
    s_add_u32 s6, s98, 4096
    s_add_u32 s7, s99, 4096
    s_mov_b32 m0, s6
    s_nop 0
    buffer_load_dwordx4 v226, s[60:63], s7 offen nt lds
    v_pk_mul_f32 v[96:97], v[96:97], v[180:181] op_sel_hi:[1,0]
    v_pk_mul_f32 v[98:99], v[98:99], v[180:181] op_sel_hi:[1,0]
    v_pk_mul_f32 v[100:101], v[100:101], v[180:181] op_sel:[0,1] op_sel_hi:[1,1]
    v_pk_mul_f32 v[102:103], v[102:103], v[180:181] op_sel:[0,1] op_sel_hi:[1,1]
    s_waitcnt lgkmcnt(2)
    v_mfma_f32_16x16x32_bf16 v[88:91], v[128:131], v[182:185], v[88:91]
    v_mfma_f32_16x16x32_bf16 v[92:95], v[128:131], v[186:189], v[92:95]
    s_waitcnt lgkmcnt(0)
    v_mfma_f32_16x16x32_bf16 v[96:99], v[132:135], v[182:185], v[96:99]
    v_mfma_f32_16x16x32_bf16 v[100:103], v[132:135], v[186:189], v[100:103]
    v_xor_b32 v210, s87, v210
    v_xor_b32 v211, s87, v211
    v_xor_b32 v212, s87, v212
    v_xor_b32 v213, s87, v213
    v_xor_b32 v214, s87, v214
    v_xor_b32 v215, s87, v215
    v_xor_b32 v216, s87, v216
    v_xor_b32 v217, s87, v217
    v_xor_b32 v218, s87, v218
    v_xor_b32 v219, s87, v219
    v_xor_b32 v220, s87, v220
    v_xor_b32 v221, s87, v221
    s_xor_b32 s87, s87, 0x18000
    s_add_u32 s89, s89, 1
    s_cmp_lt_u32 s89, 8
    s_cbranch_scc1 L_a_loop_24
    v_and_b32 v8, 15, v1
    v_lshlrev_b32 v7, 16, v8
    v_lshrrev_b32 v9, 4, v1
    v_lshlrev_b32 v9, 4, v9
    v_add_u32 v7, v7, v9
    s_lshl_b32 s6, s2, 10
    s_lshl_b32 s7, s4, 8
    s_add_u32 s6, s6, s7
    s_add_u32 s6, s6, 0x100000
    s_add_u32 s7, s6, 0x100000
    v_cvt_pk_bf16_f32 v104, v40, v41
    v_cvt_pk_bf16_f32 v105, v42, v43
    v_cvt_pk_bf16_f32 v106, v48, v49
    v_cvt_pk_bf16_f32 v107, v50, v51
    buffer_store_dwordx4 v[104:107], v7, s[52:55], s6 offen sc0 sc1
    v_cvt_pk_bf16_f32 v108, v44, v45
    v_cvt_pk_bf16_f32 v109, v46, v47
    v_cvt_pk_bf16_f32 v110, v52, v53
    v_cvt_pk_bf16_f32 v111, v54, v55
    buffer_store_dwordx4 v[108:111], v7, s[52:55], s7 offen sc0 sc1
    v_cvt_pk_bf16_f32 v112, v56, v57
    v_cvt_pk_bf16_f32 v113, v58, v59
    v_cvt_pk_bf16_f32 v114, v64, v65
    v_cvt_pk_bf16_f32 v115, v66, v67
    buffer_store_dwordx4 v[112:115], v7, s[52:55], s6 offen offset:64 sc0 sc1
    v_cvt_pk_bf16_f32 v116, v60, v61
    v_cvt_pk_bf16_f32 v117, v62, v63
    v_cvt_pk_bf16_f32 v118, v68, v69
    v_cvt_pk_bf16_f32 v119, v70, v71
    buffer_store_dwordx4 v[116:119], v7, s[52:55], s7 offen offset:64 sc0 sc1
    v_cvt_pk_bf16_f32 v120, v72, v73
    v_cvt_pk_bf16_f32 v121, v74, v75
    v_cvt_pk_bf16_f32 v122, v80, v81
    v_cvt_pk_bf16_f32 v123, v82, v83
    buffer_store_dwordx4 v[120:123], v7, s[52:55], s6 offen offset:128 sc0 sc1
    v_cvt_pk_bf16_f32 v124, v76, v77
    v_cvt_pk_bf16_f32 v125, v78, v79
    v_cvt_pk_bf16_f32 v126, v84, v85
    v_cvt_pk_bf16_f32 v127, v86, v87
    buffer_store_dwordx4 v[124:127], v7, s[52:55], s7 offen offset:128 sc0 sc1
    v_cvt_pk_bf16_f32 v128, v88, v89
    v_cvt_pk_bf16_f32 v129, v90, v91
    v_cvt_pk_bf16_f32 v130, v96, v97
    v_cvt_pk_bf16_f32 v131, v98, v99
    buffer_store_dwordx4 v[128:131], v7, s[52:55], s6 offen offset:192 sc0 sc1
    v_cvt_pk_bf16_f32 v132, v92, v93
    v_cvt_pk_bf16_f32 v133, v94, v95
    v_cvt_pk_bf16_f32 v134, v100, v101
    v_cvt_pk_bf16_f32 v135, v102, v103
    buffer_store_dwordx4 v[132:135], v7, s[52:55], s7 offen offset:192 sc0 sc1
    v_mov_b32 v198, v178
    s_nop 1
    v_permlane16_swap_b32 v178, v198
    v_add_f32 v178, v178, v198
    v_mov_b32 v198, v178
    s_nop 1
    v_permlane32_swap_b32 v178, v198
    v_add_f32 v178, v178, v198
    v_cndmask_b32 v204, v176, v177, s[94:95]
    v_mov_b32 v205, s5
    v_mov_b32 v206, v178
    v_mov_b32 v207, s5
    v_lshlrev_b32 v8, 11, v8
    s_lshr_b32 s6, s4, 1
    s_lshl_b32 s6, s6, 15
    s_and_b32 s7, s4, 1
    s_lshl_b32 s7, s7, 4
    s_add_u32 s6, s6, s7
    s_lshl_b32 s7, s2, 5
    s_add_u32 s6, s6, s7
    s_add_u32 s6, s6, 0x40000
    s_waitcnt vmcnt(0)
    s_barrier
    s_mov_b64 exec, 0xffff
    buffer_store_dwordx4 v[204:207], v8, s[52:55], s6 offen sc0 sc1
    s_mov_b64 exec, -1
    s_lshr_b32 s86, s2, 1
    s_lshl_b32 s91, s86, 11
    s_add_u32 s91, s91, 0x40000
    v_lshrrev_b32 v7, 3, v1
    v_lshlrev_b32 v8, 10, v7
    v_and_b32 v9, 7, v1
    v_lshlrev_b32 v208, 4, v9
    v_add_u32 v208, v8, v208
    v_lshlrev_b32 v209, 3, v7
    s_cmp_eq_u32 s4, 0
    s_cbranch_scc1 L_ml_lead_26
    s_barrier
    s_movk_i32 s88, 0x2000
L_mlf_retry_28:
    buffer_load_dwordx4 v[200:203], v6, s[52:55], s91 offen sc1
    buffer_load_dwordx4 v[210:213], v6, s[52:55], s91 offen offset:1024 sc1
    s_waitcnt vmcnt(0)
    v_xor_b32 v204, s5, v201
    v_bitop3_b32 v204, v204, v203, s5 bitop3:0xf6
    v_bitop3_b32 v204, v204, v211, s5 bitop3:0xf6
    v_bitop3_b32 v204, v204, v213, s5 bitop3:0xf6
    v_cmp_ne_u32 vcc, 0, v204
    s_cbranch_vccz L_mlf_ok_29
    s_sub_u32 s88, s88, 1
    s_cbranch_scc0 L_mlf_retry_28
L_mlf_ok_29:
    s_branch L_ml_go_27
L_ml_lead_26:
    s_movk_i32 s88, 0x2000
L_ml_retry_30:
    buffer_load_dwordx4 v[200:203], v6, s[52:55], s91 offen sc1
    buffer_load_dwordx4 v[210:213], v6, s[52:55], s91 offen offset:1024 sc1
    s_waitcnt vmcnt(0)
    v_xor_b32 v204, s5, v201
    v_bitop3_b32 v204, v204, v203, s5 bitop3:0xf6
    v_bitop3_b32 v204, v204, v211, s5 bitop3:0xf6
    v_bitop3_b32 v204, v204, v213, s5 bitop3:0xf6
    v_cmp_ne_u32 vcc, 0, v204
    s_cbranch_vccz L_ml_ok_31
    s_sub_u32 s88, s88, 1
    s_cbranch_scc0 L_ml_retry_30
L_ml_ok_31:
    s_barrier
L_ml_go_27:
    s_lshl_b32 s98, s86, 16
    s_lshl_b32 s7, s4, 7
    s_add_u32 s98, s98, s7
    s_and_b32 s7, s2, 1
    s_lshl_b32 s7, s7, 9
    s_add_u32 s98, s98, s7
    s_add_u32 s98, s98, 0x100000
    buffer_load_dwordx4 v[40:43], v208, s[52:55], s98 offen sc1
    s_add_u32 s98, s98, 8192
    buffer_load_dwordx4 v[44:47], v208, s[52:55], s98 offen sc1
    s_add_u32 s98, s98, 8192
    buffer_load_dwordx4 v[48:51], v208, s[52:55], s98 offen sc1
    s_add_u32 s98, s98, 8192
    buffer_load_dwordx4 v[52:55], v208, s[52:55], s98 offen sc1
    s_add_u32 s98, s98, 8192
    buffer_load_dwordx4 v[56:59], v208, s[52:55], s98 offen sc1
    s_add_u32 s98, s98, 8192
    buffer_load_dwordx4 v[60:63], v208, s[52:55], s98 offen sc1
    s_add_u32 s98, s98, 8192
    buffer_load_dwordx4 v[64:67], v208, s[52:55], s98 offen sc1
    s_add_u32 s98, s98, 8192
    buffer_load_dwordx4 v[68:71], v208, s[52:55], s98 offen sc1
    v_max_f32 v204, v200, v210
    s_nop 1
    v_max_f32_dpp v204, v204, v204 row_ror:8 row_mask:0xf bank_mask:0xf
    s_nop 1
    v_max_f32_dpp v204, v204, v204 quad_perm:[1,0,3,2] row_mask:0xf bank_mask:0xf
    s_nop 1
    v_max_f32_dpp v204, v204, v204 quad_perm:[2,3,0,1] row_mask:0xf bank_mask:0xf
    s_nop 1
    v_max_f32_dpp v204, v204, v204 row_half_mirror row_mask:0xf bank_mask:0xf
    v_mov_b32 v205, v204
    s_nop 1
    v_permlane16_swap_b32 v204, v205
    v_max_f32 v204, v204, v205
    v_mov_b32 v205, v204
    s_nop 1
    v_permlane32_swap_b32 v204, v205
    v_max_f32 v204, v204, v205
    v_sub_f32 v200, v200, v204
    v_sub_f32 v210, v210, v204
    v_exp_f32 v200, v200
    v_exp_f32 v210, v210
    v_mul_f32 v204, v200, v202
    v_fmac_f32 v204, v210, v212
    s_nop 1
    v_add_f32_dpp v204, v204, v204 row_ror:8 row_mask:0xf bank_mask:0xf
    s_nop 1
    v_add_f32_dpp v204, v204, v204 quad_perm:[1,0,3,2] row_mask:0xf bank_mask:0xf
    s_nop 1
    v_add_f32_dpp v204, v204, v204 quad_perm:[2,3,0,1] row_mask:0xf bank_mask:0xf
    s_nop 1
    v_add_f32_dpp v204, v204, v204 row_half_mirror row_mask:0xf bank_mask:0xf
    v_mov_b32 v205, v204
    s_nop 1
    v_permlane16_swap_b32 v204, v205
    v_add_f32 v204, v204, v205
    v_mov_b32 v205, v204
    s_nop 1
    v_permlane32_swap_b32 v204, v205
    v_add_f32 v204, v204, v205
    v_rcp_f32 v204, v204
    s_nop 0
    v_mul_f32 v200, v200, v204
    v_mul_f32 v210, v210, v204
    v_add_u32 v168, 0, v209
    v_add_u32 v169, 64, v209
    v_add_u32 v170, 128, v209
    v_add_u32 v171, 192, v209
    v_add_u32 v172, 0, v209
    v_add_u32 v173, 64, v209
    v_add_u32 v174, 128, v209
    v_add_u32 v175, 192, v209
    ds_bpermute_b32 v168, v168, v200
    ds_bpermute_b32 v169, v169, v200
    ds_bpermute_b32 v170, v170, v200
    ds_bpermute_b32 v171, v171, v200
    ds_bpermute_b32 v172, v172, v210
    ds_bpermute_b32 v173, v173, v210
    ds_bpermute_b32 v174, v174, v210
    ds_bpermute_b32 v175, v175, v210
    s_waitcnt lgkmcnt(0)
    s_waitcnt vmcnt(7)
    v_lshlrev_b32 v112, 16, v40
    v_and_b32 v113, 0xffff0000, v40
    v_lshlrev_b32 v114, 16, v41
    v_and_b32 v115, 0xffff0000, v41
    v_lshlrev_b32 v116, 16, v42
    v_and_b32 v117, 0xffff0000, v42
    v_lshlrev_b32 v118, 16, v43
    v_and_b32 v119, 0xffff0000, v43
    v_pk_mul_f32 v[104:105], v[112:113], v[168:169] op_sel_hi:[1,0]
    v_pk_mul_f32 v[106:107], v[114:115], v[168:169] op_sel_hi:[1,0]
    v_pk_mul_f32 v[108:109], v[116:117], v[168:169] op_sel_hi:[1,0]
    v_pk_mul_f32 v[110:111], v[118:119], v[168:169] op_sel_hi:[1,0]
    s_waitcnt vmcnt(6)
    v_lshlrev_b32 v120, 16, v44
    v_and_b32 v121, 0xffff0000, v44
    v_lshlrev_b32 v122, 16, v45
    v_and_b32 v123, 0xffff0000, v45
    v_lshlrev_b32 v124, 16, v46
    v_and_b32 v125, 0xffff0000, v46
    v_lshlrev_b32 v126, 16, v47
    v_and_b32 v127, 0xffff0000, v47
    v_pk_fma_f32 v[104:105], v[120:121], v[168:169], v[104:105] op_sel:[0,1,0] op_sel_hi:[1,1,1]
    v_pk_fma_f32 v[106:107], v[122:123], v[168:169], v[106:107] op_sel:[0,1,0] op_sel_hi:[1,1,1]
    v_pk_fma_f32 v[108:109], v[124:125], v[168:169], v[108:109] op_sel:[0,1,0] op_sel_hi:[1,1,1]
    v_pk_fma_f32 v[110:111], v[126:127], v[168:169], v[110:111] op_sel:[0,1,0] op_sel_hi:[1,1,1]
    s_waitcnt vmcnt(5)
    v_lshlrev_b32 v112, 16, v48
    v_and_b32 v113, 0xffff0000, v48
    v_lshlrev_b32 v114, 16, v49
    v_and_b32 v115, 0xffff0000, v49
    v_lshlrev_b32 v116, 16, v50
    v_and_b32 v117, 0xffff0000, v50
    v_lshlrev_b32 v118, 16, v51
    v_and_b32 v119, 0xffff0000, v51
    v_pk_fma_f32 v[104:105], v[112:113], v[170:171], v[104:105] op_sel_hi:[1,0,1]
    v_pk_fma_f32 v[106:107], v[114:115], v[170:171], v[106:107] op_sel_hi:[1,0,1]
    v_pk_fma_f32 v[108:109], v[116:117], v[170:171], v[108:109] op_sel_hi:[1,0,1]
    v_pk_fma_f32 v[110:111], v[118:119], v[170:171], v[110:111] op_sel_hi:[1,0,1]
    s_waitcnt vmcnt(4)
    v_lshlrev_b32 v120, 16, v52
    v_and_b32 v121, 0xffff0000, v52
    v_lshlrev_b32 v122, 16, v53
    v_and_b32 v123, 0xffff0000, v53
    v_lshlrev_b32 v124, 16, v54
    v_and_b32 v125, 0xffff0000, v54
    v_lshlrev_b32 v126, 16, v55
    v_and_b32 v127, 0xffff0000, v55
    v_pk_fma_f32 v[104:105], v[120:121], v[170:171], v[104:105] op_sel:[0,1,0] op_sel_hi:[1,1,1]
    v_pk_fma_f32 v[106:107], v[122:123], v[170:171], v[106:107] op_sel:[0,1,0] op_sel_hi:[1,1,1]
    v_pk_fma_f32 v[108:109], v[124:125], v[170:171], v[108:109] op_sel:[0,1,0] op_sel_hi:[1,1,1]
    v_pk_fma_f32 v[110:111], v[126:127], v[170:171], v[110:111] op_sel:[0,1,0] op_sel_hi:[1,1,1]
    s_waitcnt vmcnt(3)
    v_lshlrev_b32 v112, 16, v56
    v_and_b32 v113, 0xffff0000, v56
    v_lshlrev_b32 v114, 16, v57
    v_and_b32 v115, 0xffff0000, v57
    v_lshlrev_b32 v116, 16, v58
    v_and_b32 v117, 0xffff0000, v58
    v_lshlrev_b32 v118, 16, v59
    v_and_b32 v119, 0xffff0000, v59
    v_pk_fma_f32 v[104:105], v[112:113], v[172:173], v[104:105] op_sel_hi:[1,0,1]
    v_pk_fma_f32 v[106:107], v[114:115], v[172:173], v[106:107] op_sel_hi:[1,0,1]
    v_pk_fma_f32 v[108:109], v[116:117], v[172:173], v[108:109] op_sel_hi:[1,0,1]
    v_pk_fma_f32 v[110:111], v[118:119], v[172:173], v[110:111] op_sel_hi:[1,0,1]
    s_waitcnt vmcnt(2)
    v_lshlrev_b32 v120, 16, v60
    v_and_b32 v121, 0xffff0000, v60
    v_lshlrev_b32 v122, 16, v61
    v_and_b32 v123, 0xffff0000, v61
    v_lshlrev_b32 v124, 16, v62
    v_and_b32 v125, 0xffff0000, v62
    v_lshlrev_b32 v126, 16, v63
    v_and_b32 v127, 0xffff0000, v63
    v_pk_fma_f32 v[104:105], v[120:121], v[172:173], v[104:105] op_sel:[0,1,0] op_sel_hi:[1,1,1]
    v_pk_fma_f32 v[106:107], v[122:123], v[172:173], v[106:107] op_sel:[0,1,0] op_sel_hi:[1,1,1]
    v_pk_fma_f32 v[108:109], v[124:125], v[172:173], v[108:109] op_sel:[0,1,0] op_sel_hi:[1,1,1]
    v_pk_fma_f32 v[110:111], v[126:127], v[172:173], v[110:111] op_sel:[0,1,0] op_sel_hi:[1,1,1]
    s_waitcnt vmcnt(1)
    v_lshlrev_b32 v112, 16, v64
    v_and_b32 v113, 0xffff0000, v64
    v_lshlrev_b32 v114, 16, v65
    v_and_b32 v115, 0xffff0000, v65
    v_lshlrev_b32 v116, 16, v66
    v_and_b32 v117, 0xffff0000, v66
    v_lshlrev_b32 v118, 16, v67
    v_and_b32 v119, 0xffff0000, v67
    v_pk_fma_f32 v[104:105], v[112:113], v[174:175], v[104:105] op_sel_hi:[1,0,1]
    v_pk_fma_f32 v[106:107], v[114:115], v[174:175], v[106:107] op_sel_hi:[1,0,1]
    v_pk_fma_f32 v[108:109], v[116:117], v[174:175], v[108:109] op_sel_hi:[1,0,1]
    v_pk_fma_f32 v[110:111], v[118:119], v[174:175], v[110:111] op_sel_hi:[1,0,1]
    s_waitcnt vmcnt(0)
    v_lshlrev_b32 v120, 16, v68
    v_and_b32 v121, 0xffff0000, v68
    v_lshlrev_b32 v122, 16, v69
    v_and_b32 v123, 0xffff0000, v69
    v_lshlrev_b32 v124, 16, v70
    v_and_b32 v125, 0xffff0000, v70
    v_lshlrev_b32 v126, 16, v71
    v_and_b32 v127, 0xffff0000, v71
    v_pk_fma_f32 v[104:105], v[120:121], v[174:175], v[104:105] op_sel:[0,1,0] op_sel_hi:[1,1,1]
    v_pk_fma_f32 v[106:107], v[122:123], v[174:175], v[106:107] op_sel:[0,1,0] op_sel_hi:[1,1,1]
    v_pk_fma_f32 v[108:109], v[124:125], v[174:175], v[108:109] op_sel:[0,1,0] op_sel_hi:[1,1,1]
    v_pk_fma_f32 v[110:111], v[126:127], v[174:175], v[110:111] op_sel:[0,1,0] op_sel_hi:[1,1,1]
    v_add_f32_dpp v104, v104, v104 row_ror:8 row_mask:0xf bank_mask:0xf
    v_add_f32_dpp v105, v105, v105 row_ror:8 row_mask:0xf bank_mask:0xf
    v_add_f32_dpp v106, v106, v106 row_ror:8 row_mask:0xf bank_mask:0xf
    v_add_f32_dpp v107, v107, v107 row_ror:8 row_mask:0xf bank_mask:0xf
    v_add_f32_dpp v108, v108, v108 row_ror:8 row_mask:0xf bank_mask:0xf
    v_add_f32_dpp v109, v109, v109 row_ror:8 row_mask:0xf bank_mask:0xf
    v_add_f32_dpp v110, v110, v110 row_ror:8 row_mask:0xf bank_mask:0xf
    v_add_f32_dpp v111, v111, v111 row_ror:8 row_mask:0xf bank_mask:0xf
    v_mov_b32 v112, v104
    v_mov_b32 v113, v105
    v_mov_b32 v114, v106
    v_mov_b32 v115, v107
    v_mov_b32 v116, v108
    v_mov_b32 v117, v109
    v_mov_b32 v118, v110
    v_mov_b32 v119, v111
    v_permlane16_swap_b32 v104, v112
    v_permlane16_swap_b32 v105, v113
    v_permlane16_swap_b32 v106, v114
    v_permlane16_swap_b32 v107, v115
    v_permlane16_swap_b32 v108, v116
    v_permlane16_swap_b32 v109, v117
    v_permlane16_swap_b32 v110, v118
    v_permlane16_swap_b32 v111, v119
    v_add_f32 v104, v104, v112
    v_add_f32 v105, v105, v113
    v_add_f32 v106, v106, v114
    v_add_f32 v107, v107, v115
    v_add_f32 v108, v108, v116
    v_add_f32 v109, v109, v117
    v_add_f32 v110, v110, v118
    v_add_f32 v111, v111, v119
    v_mov_b32 v112, v104
    v_mov_b32 v113, v105
    v_mov_b32 v114, v106
    v_mov_b32 v115, v107
    v_mov_b32 v116, v108
    v_mov_b32 v117, v109
    v_mov_b32 v118, v110
    v_mov_b32 v119, v111
    v_permlane32_swap_b32 v104, v112
    v_permlane32_swap_b32 v105, v113
    v_permlane32_swap_b32 v106, v114
    v_permlane32_swap_b32 v107, v115
    v_permlane32_swap_b32 v108, v116
    v_permlane32_swap_b32 v109, v117
    v_permlane32_swap_b32 v110, v118
    v_permlane32_swap_b32 v111, v119
    v_add_f32 v104, v104, v112
    v_add_f32 v105, v105, v113
    v_add_f32 v106, v106, v114
    v_add_f32 v107, v107, v115
    v_add_f32 v108, v108, v116
    v_add_f32 v109, v109, v117
    v_add_f32 v110, v110, v118
    v_add_f32 v111, v111, v119
    v_cvt_pk_bf16_f32 v104, v104, v104
    v_cvt_pk_bf16_f32 v105, v105, v105
    v_cvt_pk_bf16_f32 v106, v106, v106
    v_cvt_pk_bf16_f32 v107, v107, v107
    v_cvt_pk_bf16_f32 v108, v108, v108
    v_cvt_pk_bf16_f32 v109, v109, v109
    v_cvt_pk_bf16_f32 v110, v110, v110
    v_cvt_pk_bf16_f32 v111, v111, v111
    s_lshl_b32 s6, s4, 9
    s_add_u32 s6, s6, 140288
    v_lshrrev_b32 v7, 2, v9
    v_lshlrev_b32 v7, 7, v7
    v_and_b32 v9, 3, v9
    v_lshlrev_b32 v9, 4, v9
    v_add3_u32 v7, v7, v9, s6
    ds_write_b128 v7, v[104:107]
    ds_write_b128 v7, v[108:111] offset:64
    v_lshrrev_b32 v8, 4, v1
    v_lshlrev_b32 v8, 2, v8
    v_add_u32 v8, s6, v8
    ds_read2_b32 v[40:41], v8 offset0:0 offset1:4
    ds_read2_b32 v[42:43], v8 offset0:8 offset1:12
    ds_read2_b32 v[44:45], v8 offset0:16 offset1:20
    ds_read2_b32 v[46:47], v8 offset0:24 offset1:28
    ds_read2_b32 v[48:49], v8 offset0:32 offset1:36
    ds_read2_b32 v[50:51], v8 offset0:40 offset1:44
    ds_read2_b32 v[52:53], v8 offset0:48 offset1:52
    ds_read2_b32 v[54:55], v8 offset0:56 offset1:60
    s_waitcnt lgkmcnt(7)
    v_and_b32 v112, v2, v40
    v_and_b32 v113, v3, v40
    v_and_b32 v114, v4, v40
    v_and_b32 v115, v5, v40
    s_nop 1
    v_mfma_f32_16x16x32_bf16 v[108:111], a[128:131], v[112:115], 0
    v_and_b32 v116, v2, v41
    v_and_b32 v117, v3, v41
    v_and_b32 v118, v4, v41
    v_and_b32 v119, v5, v41
    s_nop 1
    v_mfma_f32_16x16x32_bf16 v[108:111], a[132:135], v[116:119], v[108:111]
    s_waitcnt lgkmcnt(6)
    v_and_b32 v112, v2, v42
    v_and_b32 v113, v3, v42
    v_and_b32 v114, v4, v42
    v_and_b32 v115, v5, v42
    s_nop 1
    v_mfma_f32_16x16x32_bf16 v[108:111], a[136:139], v[112:115], v[108:111]
    v_and_b32 v116, v2, v43
    v_and_b32 v117, v3, v43
    v_and_b32 v118, v4, v43
    v_and_b32 v119, v5, v43
    s_nop 1
    v_mfma_f32_16x16x32_bf16 v[108:111], a[140:143], v[116:119], v[108:111]
    s_waitcnt lgkmcnt(5)
    v_and_b32 v112, v2, v44
    v_and_b32 v113, v3, v44
    v_and_b32 v114, v4, v44
    v_and_b32 v115, v5, v44
    s_nop 1
    v_mfma_f32_16x16x32_bf16 v[108:111], a[144:147], v[112:115], v[108:111]
    v_and_b32 v116, v2, v45
    v_and_b32 v117, v3, v45
    v_and_b32 v118, v4, v45
    v_and_b32 v119, v5, v45
    s_nop 1
    v_mfma_f32_16x16x32_bf16 v[108:111], a[148:151], v[116:119], v[108:111]
    s_waitcnt lgkmcnt(4)
    v_and_b32 v112, v2, v46
    v_and_b32 v113, v3, v46
    v_and_b32 v114, v4, v46
    v_and_b32 v115, v5, v46
    s_nop 1
    v_mfma_f32_16x16x32_bf16 v[108:111], a[152:155], v[112:115], v[108:111]
    v_and_b32 v116, v2, v47
    v_and_b32 v117, v3, v47
    v_and_b32 v118, v4, v47
    v_and_b32 v119, v5, v47
    s_nop 1
    v_mfma_f32_16x16x32_bf16 v[108:111], a[156:159], v[116:119], v[108:111]
    s_waitcnt lgkmcnt(3)
    v_and_b32 v112, v2, v48
    v_and_b32 v113, v3, v48
    v_and_b32 v114, v4, v48
    v_and_b32 v115, v5, v48
    s_nop 1
    v_mfma_f32_16x16x32_bf16 v[108:111], a[160:163], v[112:115], v[108:111]
    v_and_b32 v116, v2, v49
    v_and_b32 v117, v3, v49
    v_and_b32 v118, v4, v49
    v_and_b32 v119, v5, v49
    s_nop 1
    v_mfma_f32_16x16x32_bf16 v[108:111], a[164:167], v[116:119], v[108:111]
    s_waitcnt lgkmcnt(2)
    v_and_b32 v112, v2, v50
    v_and_b32 v113, v3, v50
    v_and_b32 v114, v4, v50
    v_and_b32 v115, v5, v50
    s_nop 1
    v_mfma_f32_16x16x32_bf16 v[108:111], a[168:171], v[112:115], v[108:111]
    v_and_b32 v116, v2, v51
    v_and_b32 v117, v3, v51
    v_and_b32 v118, v4, v51
    v_and_b32 v119, v5, v51
    s_nop 1
    v_mfma_f32_16x16x32_bf16 v[108:111], a[172:175], v[116:119], v[108:111]
    s_waitcnt lgkmcnt(1)
    v_and_b32 v112, v2, v52
    v_and_b32 v113, v3, v52
    v_and_b32 v114, v4, v52
    v_and_b32 v115, v5, v52
    s_nop 1
    v_mfma_f32_16x16x32_bf16 v[108:111], a[176:179], v[112:115], v[108:111]
    v_and_b32 v116, v2, v53
    v_and_b32 v117, v3, v53
    v_and_b32 v118, v4, v53
    v_and_b32 v119, v5, v53
    s_nop 1
    v_mfma_f32_16x16x32_bf16 v[108:111], a[180:183], v[116:119], v[108:111]
    s_waitcnt lgkmcnt(0)
    v_and_b32 v112, v2, v54
    v_and_b32 v113, v3, v54
    v_and_b32 v114, v4, v54
    v_and_b32 v115, v5, v54
    s_nop 1
    v_mfma_f32_16x16x32_bf16 v[108:111], a[184:187], v[112:115], v[108:111]
    v_and_b32 v116, v2, v55
    v_and_b32 v117, v3, v55
    v_and_b32 v118, v4, v55
    v_and_b32 v119, v5, v55
    s_nop 1
    v_mfma_f32_16x16x32_bf16 v[108:111], a[188:191], v[116:119], v[108:111]
    v_lshrrev_b32 v7, 4, v1
    v_lshlrev_b32 v7, 9, v7
    v_and_b32 v8, 7, v1
    v_lshlrev_b32 v8, 4, v8
    s_lshl_b32 s6, s4, 2
    s_add_u32 s6, s6, 143360
    v_add3_u32 v7, v7, v8, s6
    s_nop 0
    ds_write_b32 v7, v108 offset:0
    ds_write_b32 v7, v109 offset:128
    ds_write_b32 v7, v110 offset:256
    ds_write_b32 v7, v111 offset:384
    s_waitcnt lgkmcnt(0)
    s_barrier
    s_cmp_ge_u32 s4, 2
    s_cbranch_scc1 L_a_done
    s_lshl_b32 s6, s4, 10
    s_add_u32 s6, s6, 143360
    v_add_u32 v7, s6, v6
    ds_read_b128 v[40:43], v7
    s_lshl_b32 s6, s2, 10
    s_lshl_b32 s7, s4, 9
    s_add_u32 s6, s6, s7
    s_add_u32 s6, s6, 0x50000
    v_lshlrev_b32 v8, 3, v1
    s_waitcnt lgkmcnt(0)
    v_add_f32 v40, v40, v41
    v_add_f32 v42, v42, v43
    v_add_f32 v40, v40, v42
    v_mov_b32 v41, s5
    buffer_store_dwordx2 v[40:41], v8, s[52:55], s6 offen sc0 sc1
L_a_done:
    s_endpgm
L_exit:
    s_endpgm
L_codeend:
.section .rodata,"a"
.p2align 6
.amdhsa_kernel gated_mix__compressed_kv_cla__gqa_block_cached__decode_kernel
  .amdhsa_next_free_vgpr 512
  .amdhsa_next_free_sgpr 102
  .amdhsa_accum_offset 256
  .amdhsa_group_segment_fixed_size 0
  .amdhsa_kernarg_size 120
  .amdhsa_user_sgpr_count 2
  .amdhsa_user_sgpr_kernarg_segment_ptr 1
  .amdhsa_system_sgpr_workgroup_id_x 1
.end_amdhsa_kernel
```
